```python
import torch

def _softmax(x, axis=-1):
    return torch.softmax(x, dim=axis)
def _gelu(x):
    return torch.nn.functional.gelu(x, approximate="tanh")
def _silu(x):
    return torch.nn.functional.silu(x)
def _sigmoid(x):
    return torch.sigmoid(x)
def _layernorm(x, axis=-1, eps=1e-5):
    m = x.mean(dim=axis, keepdim=True)
    v = x.var(dim=axis, keepdim=True, unbiased=False)
    return (x - m) / torch.sqrt(v + eps)
def _scatter_add(tgt, idx, src, axis=0):
    return tgt.clone().index_add_(axis, idx, src)
def _segment_sum(src, seg, n):
    out = torch.zeros((n,) + src.shape[1:], dtype=src.dtype)
    return out.index_add_(0, seg, src)
def _pad(x, pw):
    flat = tuple(v for pair in reversed(pw) for v in pair)
    return torch.nn.functional.pad(x, flat)

kernel_name = 'gated_mix__ssm_conv_s4d__dense_activation_squared_relu__prompt'

def setup_inputs():

    _w = (lambda a: (lambda t: t.to(torch.bfloat16) if t.is_floating_point() else t)(torch.as_tensor(a)))
    def _A_setup():
        Bsz, L, D, N = 1, 2048, 448, 256
        return {
            "u": _w((lambda *s: torch.randn(*s, dtype=torch.bfloat16) * 0.05)(Bsz, L, D)),
            "log_A_real": _w((lambda *s: torch.randn(*s, dtype=torch.bfloat16) * 3.2)(D, N) * 0.5),
            "A_imag": _w((lambda *s: torch.randn(*s, dtype=torch.bfloat16) * 0.1)(D, N) * 3.14),
            "C_real": _w((lambda *s: torch.randn(*s, dtype=torch.bfloat16) * 0.8)(D, N) / N ** 0.5),
            "C_imag": _w((lambda *s: torch.randn(*s, dtype=torch.bfloat16) * 0.8)(D, N) / N ** 0.5),
            "log_dt": _w((lambda *s: torch.randn(*s, dtype=torch.bfloat16) * 0.1)(D) * 0.5 - 4.0),
            "D_skip": _w((lambda *s: torch.randn(*s, dtype=torch.bfloat16) * 0.1)(D)),
        }
    _A_in = _A_setup()

    def _B_setup():
        B, S, D, F = 1, 2048, 448, 1792
        return {
            "x": _w((lambda *s: torch.randn(*s, dtype=torch.bfloat16) * 0.05)(B, S, D)),
            "w1": _w((lambda *s: torch.randn(*s, dtype=torch.bfloat16) * 0.05)(D, F)),
            "b1": _w((lambda *s: torch.randn(*s, dtype=torch.bfloat16) * 0.05)(F)),
            "w2": _w((lambda *s: torch.randn(*s, dtype=torch.bfloat16) * 0.05)(F, D)),
            "b2": _w((lambda *s: torch.randn(*s, dtype=torch.bfloat16) * 0.05)(D)),
        }
    _B_in = _B_setup()

    return {
        "A_u": _A_in["u"],
        "A_log_A_real": _A_in["log_A_real"],
        "A_A_imag": _A_in["A_imag"],
        "A_C_real": _A_in["C_real"],
        "A_C_imag": _A_in["C_imag"],
        "A_log_dt": _A_in["log_dt"],
        "A_D_skip": _A_in["D_skip"],
        "B_x": _B_in["x"],
        "B_w1": _B_in["w1"],
        "B_b1": _B_in["b1"],
        "B_w2": _B_in["w2"],
        "B_b2": _B_in["b2"],
        "gate_w": _w((lambda *s: torch.randn(*s, dtype=torch.bfloat16) * 0.05)(448) * 16.0),
    }

def reference(A_u, A_log_A_real, A_A_imag, A_C_real, A_C_imag, A_log_dt, A_D_skip, B_x, B_w1, B_b1, B_w2, B_b2, gate_w):
    def _A_ref(u, log_A_real, A_imag, C_real, C_imag, log_dt, D_skip):
        L = u.shape[1]
        dt = torch.exp(log_dt)
        A = -torch.exp(log_A_real) + 1j * A_imag
        C = (C_real + 1j * C_imag) * dt[:, None]
        pos = (lambda x, dt: x.to(dt))(torch.arange(L), log_dt.dtype)
        P = torch.exp((A * dt[:, None])[:, :, None] * pos[None, None, :])
        K = 2.0 * torch.einsum("dn,dnl->dl", C, P).real
        L2 = 2 * L
        u_t = (lambda x, *d: x.permute(*d))(u, 0, 2, 1)
        Kf = (lambda x, *a, **k: torch.fft.rfft(x.float(), *a, **k))(K, L2)
        Uf = (lambda x, *a, **k: torch.fft.rfft(x.float(), *a, **k))(u_t, L2)
        y = (lambda x, *a, **k: torch.fft.irfft(x, *a, **k).to(torch.bfloat16))(Uf * Kf[None, :, :], L2)[:, :, :L]
        y = (lambda x, *d: x.permute(*d))(y, 0, 2, 1)
        return y + u * D_skip[None, None, :]

    def _B_ref(x, w1, b1, w2, b2):
        h = torch.einsum("bsd,df->bsf", x, w1) + b1
        zero = torch.zeros_like(h)
        r = torch.where(h > zero, h, zero)
        h = r * r
        out = torch.einsum("bsf,fd->bsd", h, w2) + b2
        return out

    x = A_u
    g = _sigmoid((x * gate_w).sum(-1, keepdims=True))
    a = _A_ref(x, A_log_A_real, A_A_imag, A_C_real, A_C_imag, A_log_dt, A_D_skip)
    b = _B_ref(x, B_w1, B_b1, B_w2, B_b2)
    return g * a + (1 - g) * b
```

```asm
; @launch grid=(256,1,1) block=(256,1,1) lds=163840
.amdgcn_target "amdgcn-amd-amdhsa--gfx950"
.text
.globl gated_mix__ssm_conv_s4d__dense_activation_squared_relu__prompt_kernel
.p2align 8
.type gated_mix__ssm_conv_s4d__dense_activation_squared_relu__prompt_kernel,@function
gated_mix__ssm_conv_s4d__dense_activation_squared_relu__prompt_kernel:
  s_load_dwordx8 s[24:31], s[0:1], 8
  s_load_dwordx2 s[4:5], s[0:1], 0
  s_load_dwordx2 s[8:9], s[0:1], 64
  s_load_dwordx8 s[36:43], s[0:1], 72
  s_load_dwordx2 s[12:13], s[0:1], 120
  s_load_dwordx4 s[32:35], s[0:1], 40
  s_load_dwordx2 s[16:17], s[0:1], 104
  s_sub_u32 s2, s2, 32
  s_cmp_ge_u32 s2, 224
  s_cbranch_scc0 Lmain
  s_getpc_b64 s[44:45]
Lpc:
  v_lshlrev_b32 v2, 7, v0
  v_min_u32 v2, Lhelp-Lpc, v2
  v_mov_b32 v3, s45
  v_add_co_u32 v2, vcc, s44, v2
  v_addc_co_u32 v3, vcc, 0, v3, vcc
  global_load_dword v40, v[2:3], off
  s_branch Lhelp
Lmain:
  v_lshrrev_b32 v2, 6, v0
  v_and_b32 v1, 63, v0
  s_and_b32 s44, s2, 7
  s_lshr_b32 s53, s2, 3
  v_readfirstlane_b32 s3, v2
  s_mul_i32 s45, s53, 37
  s_lshr_b32 s45, s45, 8
  s_mul_i32 s46, s45, 7
  s_sub_u32 s46, s53, s46
  s_lshl_b32 s49, s46, 3
  s_add_u32 s49, s49, s44
  s_lshl_b32 s49, s49, 2
  s_add_u32 s49, s49, s45
  s_lshr_b32 s47, s44, 1
  s_lshl_b32 s47, s47, 2
  s_add_u32 s47, s47, s45
  s_and_b32 s44, s44, 1
  s_mul_i32 s48, s44, 7
  s_add_u32 s48, s48, s46
  s_lshl_b32 s50, s45, 0
  s_add_u32 s50, s50, s46
  s_sub_u32 s53, s50, 7
  s_min_u32 s50, s50, s53
  s_lshl_b32 s67, s50, 1
  s_add_u32 s67, s67, s44
  s_lshl_b32 s50, s50, 7
  s_mul_i32 s51, s50, 1792
  s_lshl_b32 s53, s47, 2
  s_add_u32 s62, s53, s3
  s_mul_i32 s53, s62, 28672
  s_mul_i32 s54, s3, 57344
  s_lshl_b32 s55, s48, 8
  s_add_u32 s54, s54, s55
  s_mul_i32 s52, s3, 40960
  s_lshl_b32 s56, s49, 2
  s_add_u32 s59, s56, s3
  s_lshl_b32 s59, s59, 8
  v_lshrrev_b32 v64, 3, v1
  v_lshrrev_b32 v65, 4, v1
  v_mul_u32_u24 v42, 896, v64
  v_and_b32 v66, 7, v1
  v_xor_b32 v66, v66, v65
  v_lshl_add_u32 v64, v66, 4, v42
  v_add_u32 v2, s53, v64
  v_xor_b32 v64, 64, v2
  v_add_u32 v3, 6144, v64
  v_add_u32 v4, 12288, v2
  v_add_u32 v5, 18432, v64
  v_mul_u32_u24 v64, 3584, v65
  v_lshlrev_b32 v65, 2, v65
  v_xor_b32 v65, v65, v1
  v_and_b32 v65, 15, v65
  v_lshl_add_u32 v64, v65, 4, v64
  v_add_u32 v6, s54, v64
  v_add_u32 v7, 13312, v6
  v_add_u32 v8, 26624, v6
  v_add_u32 v9, 39936, v6
  v_lshrrev_b32 v64, 2, v1
  v_mul_u32_u24 v64, 3328, v64
  v_lshl_add_u32 v64, v1, 6, v64
  v_add_u32 v0, s54, v64
  v_lshl_add_u32 v67, v1, 2, s59
  v_lshl_add_u32 v68, v1, 2, s55
  v_lshlrev_b32 v38, 4, v1
  v_min_u32 v69, 880, v38
  s_lshl_b32 s53, s46, 2
  s_add_u32 s53, s53, s3
  s_lshl_b32 s53, s53, 5
  v_lshrrev_b32 v71, 5, v1
  v_lshl_add_u32 v53, v71, 4, s53
  s_lshl_b32 s53, s67, 6
  s_add_u32 s53, s53, s62
  s_mul_i32 s54, s53, 2341
  s_lshr_b32 s54, s54, 16
  s_mul_i32 s55, s54, 28
  s_sub_u32 s55, s53, s55
  s_lshl_b32 s53, s53, 11
  s_add_u32 s53, s53, 12582912
  v_add_u32 v45, s53, v38
  s_and_b32 s53, s55, 30
  s_add_u32 s55, s55, s53
  s_mul_i32 s55, s55, 7168
  s_mul_i32 s63, s54, 37
  s_lshr_b32 s63, s63, 8
  s_mul_i32 s53, s63, 400512
  s_add_u32 s55, s55, s53
  s_lshl_b32 s54, s54, 7
  s_add_u32 s55, s55, s54
  v_lshrrev_b32 v64, 2, v1
  v_and_b32 v64, 4, v64
  v_xor_b32 v64, v64, v1
  v_and_b32 v64, 7, v64
  v_lshl_add_u32 v42, v64, 4, v42
  v_add_u32 v42, s55, v42
  v_add_u32 v43, 12288, v42
  s_mov_b32 s22, 1605632
  s_mov_b32 s23, 0x20000
  s_mov_b32 s6, 1835008
  s_mov_b32 s7, 0x20000
  s_mov_b32 s10, 1605632
  s_mov_b32 s11, 0x20000
  s_waitcnt lgkmcnt(0)
  s_load_dword s57, s[32:33], s56
  s_load_dword s58, s[34:35], s56
  s_load_dword s61, s[12:13], 0
  global_load_dword v252, v67, s[24:25]
  global_load_dword v253, v67, s[26:27]
  global_load_dword v254, v67, s[28:29]
  global_load_dword v255, v67, s[30:31]
  s_add_u32 m0, s52, 0
  s_mov_b32 s20, s38
  buffer_load_dwordx4 v2, s[4:7], s50 offen offset:0 lds
  buffer_load_dwordx4 v3, s[4:7], s50 offen offset:1024 lds
  buffer_load_dwordx4 v4, s[4:7], s50 offen offset:2048 lds
  buffer_load_dwordx4 v5, s[4:7], s50 offen offset:3072 lds
  s_add_u32 m0, s52, 4096
  s_mov_b32 s21, s39
  buffer_load_dwordx4 v6, s[8:11], s51 offen offset:0 lds
  buffer_load_dwordx4 v7, s[8:11], s51 offen offset:1024 lds
  buffer_load_dwordx4 v8, s[8:11], s51 offen offset:2048 lds
  buffer_load_dwordx4 v9, s[8:11], s51 offen offset:3072 lds
  s_add_u32 m0, s52, 34816
  s_add_u32 s0, s45, 1
  buffer_load_dwordx4 v42, s[20:23], 0 offen offset:0 lds
  buffer_load_dwordx4 v43, s[20:23], 0 offen offset:2048 lds
  s_and_b32 s0, s0, 3
  s_add_u32 m0, s52, 40192
  s_add_u32 s0, s0, s46
  global_load_lds_dword v68, s[36:37]
  s_sub_u32 s1, s0, 7
  s_add_u32 m0, s52, 39168
  s_min_u32 s0, s0, s1
  global_load_lds_dwordx4 v69, s[42:43]
  s_lshl_b32 s0, s0, 7
  global_load_dwordx4 v[56:59], v53, s[40:41]
  s_mul_i32 s1, s0, 1792
  s_lshr_b32 s53, s3, 1
  s_lshl_b32 s55, s53, 1
  s_and_b32 s54, s3, 1
  v_bfe_u32 v73, v1, 2, 2
  v_and_b32 v81, 3, v1
  v_and_b32 v74, 1, v1
  v_lshl_add_u32 v81, v81, 3, v73
  v_lshlrev_b32 v81, 7, v81
  v_xor_b32 v82, s44, v74
  s_lshl_b32 s56, s54, 11
  s_mul_i32 s64, s3, 7
  s_add_u32 s64, s64, s46
  s_lshl_b32 s59, s47, 1
  s_add_u32 s47, s59, s44
  s_add_u32 s59, s59, s54
  s_mul_i32 s59, s59, 28
  s_waitcnt lgkmcnt(0)
  s_lshr_b32 s32, s49, 1
  s_lshl_b32 s32, s32, 2
  s_mul_i32 s34, s47, 28
  s_lshl_b32 s40, s49, 2
  v_and_b32 v77, 8, v1
  v_lshl_add_u32 v81, v82, 6, v81
  v_lshrrev_b32 v82, 3, v77
  v_xor_b32 v82, v82, v71
  v_and_b32 v75, 16, v1
  v_lshl_add_u32 v81, v82, 4, v81
  v_lshrrev_b32 v82, 1, v75
  v_add3_u32 v88, v81, v82, s52
  s_add_u32 s32, s32, s3
  s_add_u32 s40, s40, s3
  s_lshl_b32 s32, s32, 7
  s_lshl_b32 s39, s40, 11
  s_mul_i32 s61, s61, 0x9E3779B1
  s_lshl_b32 s40, s40, 7
  s_add_u32 s61, s61, 0x7F4A7C15
  s_mov_b32 s14, 14188544
  s_mov_b32 s15, 0x20000
  s_mov_b32 s18, 1835008
  s_mov_b32 s19, 0x20000
  s_mov_b32 s100, 0xaaaaaaaa
  v_lshl_add_u32 v81, v71, 3, v73
  v_lshlrev_b32 v81, 8, v81
  v_xor_b32 v82, s55, v73
  v_lshl_add_u32 v81, v82, 6, v81
  v_lshl_add_u32 v81, v74, 5, v81
  v_and_b32 v76, 2, v1
  v_add_u32 v81, v75, v81
  v_lshl_add_u32 v81, v76, 2, v81
  s_mul_i32 s55, s54, 81920
  s_mov_b32 s101, 0xaaaaaaaa
  s_mov_b32 s66, 65408
  s_add_u32 s39, s39, 3145728
  s_add_u32 s40, s40, 327680
  s_mul_i32 s43, s47, 57344
  s_cmp_lg_u32 s3, 0
  s_cselect_b32 s33, -1, 0
  s_add_u32 s24, s45, 2
  v_add_u32 v10, 4096, v81
  v_bfe_u32 v82, v1, 1, 3
  v_xor_b32 v81, v82, v71
  v_and_b32 v78, 31, v1
  v_lshlrev_b32 v81, 4, v81
  v_lshl_add_u32 v81, v78, 7, v81
  v_add_u32 v14, s55, v81
  v_lshrrev_b32 v80, 4, v1
  s_lshl_b32 s55, s44, 1
  v_xor_b32 v81, v82, v80
  s_add_u32 s55, s55, s53
  s_mul_i32 s55, s55, 40960
  s_add_u32 s55, s55, s56
  s_lshl_b32 s56, s54, 8
  s_lshr_b32 s54, s47, 3
  s_and_b32 s24, s24, 3
  s_lshl_b32 s28, s45, 2
  v_and_b32 v79, 15, v1
  v_lshlrev_b32 v81, 4, v81
  v_lshl_add_u32 v81, v79, 7, v81
  v_add_u32 v18, s55, v81
  v_lshlrev_b32 v82, 2, v82
  s_mul_i32 s55, s53, 2176
  v_lshl_add_u32 v82, v80, 4, v82
  v_mul_u32_u24 v81, 1088, v74
  s_sub_u32 s55, s55, s56
  v_sub_u32 v82, v82, v81
  s_add_u32 s55, s55, 36164
  v_add_u32 v20, s55, v82
  s_sub_u32 s55, s52, s56
  v_lshlrev_b32 v81, 5, v79
  s_add_u32 s55, s55, 25312
  s_add_u32 s24, s24, s46
  s_add_u32 s26, s45, 3
  s_lshr_b32 s28, 21605, s28
  v_lshlrev_b32 v82, 4, v80
  v_sub_u32 v81, v82, v81
  v_add_u32 v24, s55, v81
  v_lshlrev_b32 v81, 4, v79
  v_lshl_add_u32 v34, v80, 14, v81
  v_mul_u32_u24 v81, 272, v78
  v_lshl_add_u32 v81, v71, 4, v81
  v_add_u32 v25, s52, v81
  s_lshl_b32 s55, s53, 7
  v_lshl_add_u32 v81, v71, 4, v73
  s_add_u32 s55, s55, s52
  v_lshlrev_b32 v81, 7, v81
  v_lshl_add_u32 v90, v71, 5, s55
  v_lshl_add_u32 v81, v74, 4, v81
  v_lshl_add_u32 v81, v75, 1, v81
  s_xor_b32 s55, s63, 3
  s_and_b32 s55, s55, 3
  s_lshl_b32 s56, s55, 5
  s_xor_b32 s55, s3, 3
  v_lshl_add_u32 v81, v76, 2, v81
  v_lshl_add_u32 v81, v77, 3, v81
  v_xor_b32 v81, s56, v81
  s_mul_i32 s56, s55, 40960
  v_add_u32 v46, s52, v81
  s_mul_i32 s55, s64, 3584
  v_add_u32 v91, s52, v82
  s_add_u32 s55, s55, 128
  v_min_u32 v44, 27, v1
  v_lshrrev_b32 v81, 1, v1
  v_lshl_add_u32 v44, v44, 7, s55
  v_lshlrev_b32 v31, 6, v81
  v_mul_u32_u24 v82, 2176, v74
  v_lshl_add_u32 v81, v81, 4, v82
  s_add_u32 s55, s52, 34816
  v_add_u32 v32, s55, v81
  s_lshl_b32 s55, s3, 4
  s_mul_i32 s64, s64, 57344
  s_add_u32 s64, s64, 12582912
  v_min_u32 v81, 16, v1
  v_add_u32 v81, s55, v81
  s_lshr_b32 s55, s49, 4
  v_max_u32 v81, 1, v81
  s_lshl_b32 s55, s55, 13
  v_lshl_add_u32 v81, v81, 7, s55
  s_lshl_b32 s55, s62, 7
  v_min_u32 v82, 13, v78
  s_add_u32 s55, s55, 128
  v_lshl_add_u32 v82, v82, 13, s55
  v_sub_u32 v82, v82, v81
  s_getreg_b32 s55, hwreg(HW_REG_XCC_ID, 0, 16)
  v_mad_i32_i24 v33, v82, v71, v81
  v_mov_b32 v41, s55
  v_lshlrev_b32 v81, 4, v78
  s_add_u32 s55, s52, 26096
  v_sub_u32 v81, s55, v81
  v_lshlrev_b32 v82, 3, v71
  s_add_u32 s55, s52, 24576
  s_sub_u32 s25, s24, 7
  v_sub_u32 v27, v81, v82
  v_lshlrev_b32 v82, 9, v71
  v_sub_u32 v28, v81, v82
  v_lshrrev_b32 v81, 4, v78
  v_mul_u32_u24 v81, 40960, v81
  v_lshl_add_u32 v54, v79, 2, v81
  v_min_u32 v81, 6, v1
  v_lshlrev_b32 v35, 7, v81
  v_lshl_add_u32 v81, v79, 2, v80
  v_xor_b32 v81, v81, v73
  v_lshl_add_u32 v48, v81, 4, s55
  s_lshl_b32 s55, s3, 11
  v_xor_b32 v81, v80, v1
  s_add_u32 s55, s55, 24576
  v_lshl_add_u32 v49, v81, 4, s55
  s_lshl_b32 s55, s48, 1
  s_add_u32 s55, s55, s53
  s_add_u32 s65, s59, s55
  s_lshl_b32 s55, s67, 6
  s_lshl_b32 s67, s67, 9
  s_add_u32 s55, s55, s62
  s_add_u32 s67, s67, s62
  s_lshl_b32 s53, s46, 2
  s_lshl_b32 s62, s55, 7
  s_add_u32 s53, s53, s3
  s_lshl_b32 s55, s53, 5
  s_add_u32 s41, s55, s54
  s_lshl_b32 s53, s53, 16
  s_lshl_b32 s54, s47, 8
  s_add_u32 s42, s53, s54
  s_mul_i32 s54, s3, 7
  s_add_u32 s54, s54, s34
  s_lshr_b32 s53, s3, 1
  s_add_u32 s59, s59, s65
  s_and_b32 s55, s49, 1
  s_add_u32 s35, s54, s34
  v_add_u32 v60, s56, v38
  s_xor_b32 s56, s3, 2
  s_mul_i32 s56, s56, 40960
  s_lshl_b32 s53, s53, 4
  s_lshl_b32 s59, s59, 12
  s_lshl_b32 s67, s67, 8
  s_add_u32 s32, s32, s55
  s_lshl_b32 s35, s35, 12
  s_lshr_b32 s58, s58, s53
  s_lshl_b32 s65, s65, 7
  s_add_u32 s59, s59, 5242880
  s_add_u32 s67, s67, 1048576
  s_lshl_b32 s41, s41, 7
  s_lshl_b32 s32, s32, 5
  s_add_u32 s35, s35, 5242880
  s_lshl_b32 s34, s54, 7
  s_lshr_b32 s57, s57, s53
  s_lshl_b32 s58, s58, 16
  s_add_u32 s65, s65, 196608
  v_and_b32 v81, 7, v1
  v_lshlrev_b32 v51, 9, v81
  v_add_u32 v61, s56, v38
  s_xor_b32 s56, s3, 1
  s_mul_i32 s56, s56, 40960
  s_add_u32 s60, s59, 114688
  s_add_u32 s48, s67, 65536
  s_add_u32 s62, s62, 65536
  s_add_u32 s41, s41, 327680
  s_add_u32 s42, s42, 3145728
  s_add_u32 s32, s32, 1048448
  s_add_u32 s38, s35, 114688
  s_add_u32 s34, s34, 196608
  s_lshl_b32 s57, s57, 16
  v_mul_u32_u24 v81, 896, v78
  v_add_u32 v53, v53, v81
  v_xor_b32 v11, 64, v10
  v_lshlrev_b32 v81, 2, v78
  v_mov_b32 v30, 0
  v_xor_b32 v89, 32, v88
  v_add_u32 v12, 81920, v10
  v_add_u32 v13, 81920, v11
  v_xor_b32 v15, 32, v14
  s_waitcnt vmcnt(15)
  v_xor_b32 v16, 64, v14
  v_xor_b32 v17, 96, v14
  v_xor_b32 v19, 64, v18
  v_add_u32 v21, 40960, v20
  v_add_u32 v22, 81920, v20
  v_add_u32 v23, 122880, v20
  v_xor_b32 v47, 64, v46
  v_add_u32 v62, s56, v38
  v_add_u32 v39, s52, v38
  v_lshl_add_u32 v31, v74, 4, v31
  v_sub_u32 v29, v28, v82
  v_add_u32 v55, 81920, v54
  v_add_u32 v50, 81920, v49
  v_lshl_add_u32 v52, v71, 15, v81
  v_mov_b32 v40, s61
  v_writelane_b32 v30, s58, 0
  v_mov_b32 v96, 1069066811
  v_mul_f32 v96, s57, v96
  v_lshlrev_b32 v98, 16, v252
  s_waitcnt vmcnt(13)
  s_and_b32 s26, s26, 3
  s_and_b32 s28, s28, 7
  s_lshl_b32 s30, s45, 2
  s_lshl_b32 s36, s45, 2
  s_min_u32 s24, s24, s25
  s_add_u32 s26, s26, s46
  s_add_u32 s28, s28, s46
  s_lshr_b32 s30, 25926, s30
  s_lshr_b32 s36, 18004, s36
  v_and_b32 v99, 0xffff0000, v252
  v_exp_f32 v96, v96
  v_mul_f32 v98, 1069066811, v98
  v_mul_f32 v99, 1069066811, v99
  v_exp_f32 v98, v98
  v_exp_f32 v99, v99
  v_cvt_pk_bf16_f32 v96, v96, v96
  s_add_u32 m0, s52, 8192
  s_lshl_b32 s24, s24, 7
  buffer_load_dwordx4 v2, s[4:7], s0 offen offset:0 lds
  s_sub_u32 s27, s26, 7
  s_sub_u32 s29, s28, 7
  s_and_b32 s30, s30, 7
  s_and_b32 s36, s36, 7
  s_min_u32 s26, s26, s27
  s_min_u32 s28, s28, s29
  v_lshlrev_b32 v96, 16, v96
  v_lshlrev_b32 v100, 16, v253
  v_cvt_pk_bf16_f32 v99, v98, v99
  v_mul_f32 v100, v100, v96
  v_lshlrev_b32 v98, 16, v99
  v_mul_f32 v100, 0.15915494, v100
  v_mul_f32 v98, v98, v96
  v_and_b32 v101, 0xffff0000, v253
  v_mul_f32 v98, 3216550459, v98
  buffer_load_dwordx4 v3, s[4:7], s0 offen offset:1024 lds
  s_add_u32 s30, s30, s46
  s_add_u32 s36, s36, s46
  s_lshl_b32 s26, s26, 7
  s_lshl_b32 s28, s28, 7
  v_fract_f32 v103, v100
  v_mul_f32 v101, v101, v96
  v_and_b32 v99, 0xffff0000, v99
  v_exp_f32 v102, v98
  v_cos_f32 v108, v103
  v_sin_f32 v109, v103
  v_mul_f32 v101, 0.15915494, v101
  v_mul_f32 v99, v99, v96
  v_mul_f32 v99, 3216550459, v99
  v_mul_f32 v108, v108, v102
  buffer_load_dwordx4 v4, s[4:7], s0 offen offset:2048 lds
  s_sub_u32 s31, s30, 7
  s_sub_u32 s37, s36, 7
  s_min_u32 s30, s30, s31
  s_min_u32 s36, s36, s37
  v_mul_f32 v109, v109, v102
  v_mul_f32 v103, 0x42000000, v101
  v_mul_f32 v102, 0x42000000, v99
  v_fract_f32 v103, v103
  v_exp_f32 v102, v102
  v_cos_f32 v114, v103
  v_sin_f32 v115, v103
  v_mul_f32 v114, v114, v102
  v_mul_f32 v115, v115, v102
  v_cvt_pk_f16_f32 v192, v108, v109
  buffer_load_dwordx4 v5, s[4:7], s0 offen offset:3072 lds
  s_lshl_b32 s30, s30, 7
  s_lshl_b32 s36, s36, 7
  s_mul_i32 s25, s24, 1792
  v_pk_mul_f32 v[102:103], v[108:109], v[108:109] op_sel:[0,0] op_sel_hi:[0,1]
  v_pk_fma_f32 v[108:109], v[108:109], v[108:109], v[102:103] op_sel:[1,1,0] op_sel_hi:[1,0,1] neg_lo:[1,0,0]
  v_pk_mul_f32 v[102:103], v[114:115], v[114:115] op_sel:[0,0] op_sel_hi:[0,1]
  v_cvt_pk_f16_f32 v208, v114, v115
  v_pk_fma_f32 v[114:115], v[114:115], v[114:115], v[102:103] op_sel:[1,1,0] op_sel_hi:[1,0,1] neg_lo:[1,0,0]
  v_pk_mul_f32 v[102:103], v[108:109], v[108:109] op_sel:[0,0] op_sel_hi:[0,1]
  v_cvt_pk_f16_f32 v193, v108, v109
  v_mul_f32 v105, 0x42000000, v100
  v_mul_f32 v104, 0x42000000, v98
  s_add_u32 m0, s52, 12288
  s_mul_i32 s27, s26, 1792
  buffer_load_dwordx4 v6, s[8:11], s1 offen offset:0 lds
  v_pk_fma_f32 v[108:109], v[108:109], v[108:109], v[102:103] op_sel:[1,1,0] op_sel_hi:[1,0,1] neg_lo:[1,0,0]
  v_fract_f32 v105, v105
  v_exp_f32 v104, v104
  v_cos_f32 v110, v105
  v_sin_f32 v111, v105
  v_pk_mul_f32 v[102:103], v[114:115], v[114:115] op_sel:[0,0] op_sel_hi:[0,1]
  v_cvt_pk_f16_f32 v209, v114, v115
  v_mul_f32 v110, v110, v104
  v_mul_f32 v111, v111, v104
  v_fract_f32 v107, v101
  buffer_load_dwordx4 v7, s[8:11], s1 offen offset:1024 lds
  v_pk_fma_f32 v[114:115], v[114:115], v[114:115], v[102:103] op_sel:[1,1,0] op_sel_hi:[1,0,1] neg_lo:[1,0,0]
  v_pk_mul_f32 v[104:105], v[110:111], v[110:111] op_sel:[0,0] op_sel_hi:[0,1]
  v_cvt_pk_f16_f32 v197, v110, v111
  v_pk_mul_f32 v[102:103], v[108:109], v[108:109] op_sel:[0,0] op_sel_hi:[0,1]
  v_exp_f32 v106, v99
  v_cos_f32 v112, v107
  v_sin_f32 v113, v107
  v_pk_fma_f32 v[110:111], v[110:111], v[110:111], v[104:105] op_sel:[1,1,0] op_sel_hi:[1,0,1] neg_lo:[1,0,0]
  v_cvt_pk_f16_f32 v194, v108, v109
  v_mul_f32 v112, v112, v106
  buffer_load_dwordx4 v8, s[8:11], s1 offen offset:2048 lds
  s_mul_i32 s29, s28, 1792
  s_mul_i32 s31, s30, 1792
  s_mul_i32 s37, s36, 1792
  v_pk_fma_f32 v[108:109], v[108:109], v[108:109], v[102:103] op_sel:[1,1,0] op_sel_hi:[1,0,1] neg_lo:[1,0,0]
  v_mul_f32 v113, v113, v106
  v_pk_mul_f32 v[104:105], v[110:111], v[110:111] op_sel:[0,0] op_sel_hi:[0,1]
  v_lshlrev_b32 v118, 16, v254
  v_lshlrev_b32 v119, 16, v255
  v_and_b32 v120, 0xffff0000, v254
  v_pk_mul_f32 v[106:107], v[112:113], v[112:113] op_sel:[0,0] op_sel_hi:[0,1]
  v_cvt_pk_f16_f32 v198, v110, v111
  v_pk_mul_f32 v[102:103], v[114:115], v[114:115] op_sel:[0,0] op_sel_hi:[0,1]
  v_and_b32 v121, 0xffff0000, v255
  buffer_load_dwordx4 v9, s[8:11], s1 offen offset:3072 lds
  v_max3_f32 v116, |v118|, |v119|, |v120|
  v_cvt_pk_f16_f32 v203, v112, v113
  v_pk_fma_f32 v[110:111], v[110:111], v[110:111], v[104:105] op_sel:[1,1,0] op_sel_hi:[1,0,1] neg_lo:[1,0,0]
  v_cvt_pk_f16_f32 v210, v114, v115
  v_max_f32 v116, v116, |v121|
  v_add_u32 v92, s50, v91
  v_cvt_pk_f16_f32 v195, v108, v109
  v_add_u32 v93, s0, v91
  s_add_u32 m0, s52, 16384
  v_pk_fma_f32 v[112:113], v[112:113], v[112:113], v[106:107] op_sel:[1,1,0] op_sel_hi:[1,0,1] neg_lo:[1,0,0]
  v_pk_fma_f32 v[114:115], v[114:115], v[114:115], v[102:103] op_sel:[1,1,0] op_sel_hi:[1,0,1] neg_lo:[1,0,0]
  v_max_u32_dpp v116, v116, v116 row_shr:1 row_mask:0xf bank_mask:0xf
  v_pk_mul_f32 v[104:105], v[110:111], v[110:111] op_sel:[0,0] op_sel_hi:[0,1]
  v_pk_mul_f32 v[106:107], v[112:113], v[112:113] op_sel:[0,0] op_sel_hi:[0,1]
  v_cvt_pk_f16_f32 v199, v110, v111
  v_pk_mul_f16 v221, v195, v197 op_sel:[0,0] op_sel_hi:[0,1]
  v_max_u32_dpp v116, v116, v116 row_shr:2 row_mask:0xf bank_mask:0xf
  v_pk_mul_f32 v[102:103], v[108:109], v[108:109] op_sel:[0,0] op_sel_hi:[0,1]
  v_cvt_pk_f16_f32 v204, v112, v113
  v_max_u32_dpp v116, v116, v116 row_shr:4 row_mask:0xf bank_mask:0xf
  v_pk_fma_f32 v[110:111], v[110:111], v[110:111], v[104:105] op_sel:[1,1,0] op_sel_hi:[1,0,1] neg_lo:[1,0,0]
  v_pk_fma_f32 v[112:113], v[112:113], v[112:113], v[106:107] op_sel:[1,1,0] op_sel_hi:[1,0,1] neg_lo:[1,0,0]
  v_max_u32_dpp v116, v116, v116 row_shr:8 row_mask:0xf bank_mask:0xf
  v_cvt_pk_f16_f32 v211, v114, v115
  v_pk_fma_f16 v221, v195, v197, v221 op_sel:[1,1,0] op_sel_hi:[1,0,1] neg_lo:[1,0,0]
  v_pk_fma_f32 v[108:109], v[108:109], v[108:109], v[102:103] op_sel:[1,1,0] op_sel_hi:[1,0,1] neg_lo:[1,0,0]
  v_max_u32_dpp v116, v116, v116 row_bcast:15 row_mask:0xa bank_mask:0xf
  v_pk_mul_f32 v[104:105], v[110:111], v[110:111] op_sel:[0,0] op_sel_hi:[0,1]
  v_pk_mul_f32 v[106:107], v[112:113], v[112:113] op_sel:[0,0] op_sel_hi:[0,1]
  v_max_u32_dpp v116, v116, v116 row_bcast:31 row_mask:0xc bank_mask:0xf
  v_cvt_pk_f16_f32 v200, v110, v111
  v_readlane_b32 s53, v116, 63
  v_cvt_pk_f16_f32 v205, v112, v113
  v_mov_b32 v216, 0x3c00
  s_lshr_b32 s53, s53, 23
  s_max_u32 s53, s53, 14
  s_sub_u32 s54, 267, s53
  s_sub_u32 s53, s53, 12
  v_pk_mul_f32 v[102:103], v[114:115], v[114:115] op_sel:[0,0] op_sel_hi:[0,1]
  v_pk_fma_f32 v[110:111], v[110:111], v[110:111], v[104:105] op_sel:[1,1,0] op_sel_hi:[1,0,1] neg_lo:[1,0,0]
  v_pk_fma_f32 v[112:113], v[112:113], v[112:113], v[106:107] op_sel:[1,1,0] op_sel_hi:[1,0,1] neg_lo:[1,0,0]
  v_cvt_pk_f16_f32 v196, v108, v109
  s_lshl_b32 s53, s53, 23
  s_lshl_b32 s54, s54, 23
  v_pk_fma_f32 v[114:115], v[114:115], v[114:115], v[102:103] op_sel:[1,1,0] op_sel_hi:[1,0,1] neg_lo:[1,0,0]
  v_pk_mul_f32 v[104:105], v[110:111], v[110:111] op_sel:[0,0] op_sel_hi:[0,1]
  v_pk_mul_f32 v[106:107], v[112:113], v[112:113] op_sel:[0,0] op_sel_hi:[0,1]
  v_cvt_pk_f16_f32 v201, v110, v111
  v_cvt_pk_f16_f32 v206, v112, v113
  v_pk_mul_f32 v[102:103], v[114:115], v[114:115] op_sel:[0,0] op_sel_hi:[0,1]
  v_pk_fma_f32 v[110:111], v[110:111], v[110:111], v[104:105] op_sel:[1,1,0] op_sel_hi:[1,0,1] neg_lo:[1,0,0]
  v_cvt_pk_f16_f32 v212, v114, v115
  v_pk_fma_f32 v[112:113], v[112:113], v[112:113], v[106:107] op_sel:[1,1,0] op_sel_hi:[1,0,1] neg_lo:[1,0,0]
  v_pk_fma_f32 v[114:115], v[114:115], v[114:115], v[102:103] op_sel:[1,1,0] op_sel_hi:[1,0,1] neg_lo:[1,0,0]
  v_mul_f32 v63, s53, v96
  v_mul_f32 v118, s54, v118
  v_mul_f32 v119, s54, v119
  v_cvt_pk_f16_f32 v202, v110, v111
  v_mul_f32 v120, s54, v120
  v_mul_f32 v121, s54, v121
  v_cvt_pk_f16_f32 v214, v118, -v119
  v_cvt_pk_f16_f32 v215, v120, -v121
  v_cvt_pk_f16_f32 v207, v112, v113
  v_cvt_pk_f16_f32 v213, v114, v115
  v_pk_mul_f16 v224, v214, v192 op_sel:[0,0] op_sel_hi:[1,0]
  v_pk_fma_f16 v224, v214, v192, v224 op_sel:[1,1,0] op_sel_hi:[0,1,1] neg_hi:[1,0,0]
  v_pk_mul_f16 v227, v214, v194 op_sel:[0,0] op_sel_hi:[1,0]
  v_pk_mul_f16 v220, v195, v196 op_sel:[0,0] op_sel_hi:[0,1]
  v_pk_mul_f16 v222, v196, v197 op_sel:[0,0] op_sel_hi:[0,1]
  ds_write_addtid_b32 v224 offset:10000
  ds_write_addtid_b32 v214 offset:9728
  v_pk_mul_f16 v225, v214, v193 op_sel:[0,0] op_sel_hi:[1,0]
  v_pk_mul_f16 v226, v224, v193 op_sel:[0,0] op_sel_hi:[1,0]
  v_pk_fma_f16 v227, v214, v194, v227 op_sel:[1,1,0] op_sel_hi:[0,1,1] neg_hi:[1,0,0]
  v_pk_mul_f16 v217, v214, v200 op_sel:[0,0] op_sel_hi:[1,0]
  v_pk_fma_f16 v225, v214, v193, v225 op_sel:[1,1,0] op_sel_hi:[0,1,1] neg_hi:[1,0,0]
  v_pk_fma_f16 v226, v224, v193, v226 op_sel:[1,1,0] op_sel_hi:[0,1,1] neg_hi:[1,0,0]
  v_pk_mul_f16 v228, v224, v194 op_sel:[0,0] op_sel_hi:[1,0]
  v_pk_mul_f16 v218, v214, v201 op_sel:[0,0] op_sel_hi:[1,0]
  ds_write_addtid_b32 v227 offset:10816
  ds_write_addtid_b32 v226 offset:10544
  ds_write_addtid_b32 v225 offset:10272
  v_pk_fma_f16 v217, v214, v200, v217 op_sel:[1,1,0] op_sel_hi:[0,1,1] neg_hi:[1,0,0]
  v_pk_fma_f16 v228, v224, v194, v228 op_sel:[1,1,0] op_sel_hi:[0,1,1] neg_hi:[1,0,0]
  v_pk_mul_f16 v229, v225, v194 op_sel:[0,0] op_sel_hi:[1,0]
  v_pk_mul_f16 v230, v226, v194 op_sel:[0,0] op_sel_hi:[1,0]
  v_pk_mul_f16 v231, v217, v193 op_sel:[0,0] op_sel_hi:[1,0]
  v_pk_fma_f16 v218, v214, v201, v218 op_sel:[1,1,0] op_sel_hi:[0,1,1] neg_hi:[1,0,0]
  v_pk_fma_f16 v220, v195, v196, v220 op_sel:[1,1,0] op_sel_hi:[1,0,1] neg_lo:[1,0,0]
  ds_write_addtid_b32 v228 offset:11088
  v_pk_mul_f16 v219, v217, v201 op_sel:[0,0] op_sel_hi:[1,0]
  v_pk_mul_f16 v227, v214, v202 op_sel:[0,0] op_sel_hi:[1,0]
  v_pk_fma_f16 v229, v225, v194, v229 op_sel:[1,1,0] op_sel_hi:[0,1,1] neg_hi:[1,0,0]
  v_pk_fma_f16 v230, v226, v194, v230 op_sel:[1,1,0] op_sel_hi:[0,1,1] neg_hi:[1,0,0]
  v_pk_fma_f16 v231, v217, v193, v231 op_sel:[1,1,0] op_sel_hi:[0,1,1] neg_hi:[1,0,0]
  v_pk_fma_f16 v219, v217, v201, v219 op_sel:[1,1,0] op_sel_hi:[0,1,1] neg_hi:[1,0,0]
  v_pk_fma_f16 v227, v214, v202, v227 op_sel:[1,1,0] op_sel_hi:[0,1,1] neg_hi:[1,0,0]
  v_pk_mul_f16 v224, v218, v195 op_sel:[0,0] op_sel_hi:[1,0]
  v_pk_mul_f16 v223, v220, v197 op_sel:[0,0] op_sel_hi:[0,1]
  ds_write_addtid_b32 v229 offset:11360
  ds_write_addtid_b32 v230 offset:11632
  ds_write_addtid_b32 v231 offset:12176
  v_pk_mul_f16 v233, v231, v194 op_sel:[0,0] op_sel_hi:[1,0]
  v_pk_mul_f16 v226, v219, v195 op_sel:[0,0] op_sel_hi:[1,0]
  v_pk_mul_f16 v228, v227, v195 op_sel:[0,0] op_sel_hi:[1,0]
  v_pk_fma_f16 v233, v231, v194, v233 op_sel:[1,1,0] op_sel_hi:[0,1,1] neg_hi:[1,0,0]
  v_pk_fma_f16 v224, v218, v195, v224 op_sel:[1,1,0] op_sel_hi:[0,1,1] neg_hi:[1,0,0]
  v_pk_mul_f16 v232, v217, v194 op_sel:[0,0] op_sel_hi:[1,0]
  v_pk_mul_f16 v234, v217, v195 op_sel:[0,0] op_sel_hi:[1,0]
  s_waitcnt vmcnt(17)
  ds_read_b64_tr_b16 a[236:237], v88 offset:0
  ds_read_b64_tr_b16 a[238:239], v89 offset:512
  ds_read_b64_tr_b16 a[240:241], v89 offset:0
  ds_read_b64_tr_b16 a[242:243], v88 offset:512
  ds_write_addtid_b32 v233 offset:13264
  ds_write_addtid_b32 v224 offset:14624
  v_pk_fma_f16 v226, v219, v195, v226 op_sel:[1,1,0] op_sel_hi:[0,1,1] neg_hi:[1,0,0]
  v_pk_fma_f16 v228, v227, v195, v228 op_sel:[1,1,0] op_sel_hi:[0,1,1] neg_hi:[1,0,0]
  v_pk_mul_f16 v229, v217, v202 op_sel:[0,0] op_sel_hi:[1,0]
  ds_write_addtid_b32 v226 offset:15712
  ds_write_addtid_b32 v228 offset:16528
  v_pk_mul_f16 v225, v219, v194 op_sel:[0,0] op_sel_hi:[1,0]
  v_pk_fma_f16 v229, v217, v202, v229 op_sel:[1,1,0] op_sel_hi:[0,1,1] neg_hi:[1,0,0]
  v_pk_fma_f16 v222, v196, v197, v222 op_sel:[1,1,0] op_sel_hi:[1,0,1] neg_lo:[1,0,0]
  v_pk_fma_f16 v223, v220, v197, v223 op_sel:[1,1,0] op_sel_hi:[1,0,1] neg_lo:[1,0,0]
  v_pk_fma_f16 v232, v217, v194, v232 op_sel:[1,1,0] op_sel_hi:[0,1,1] neg_hi:[1,0,0]
  v_pk_fma_f16 v234, v217, v195, v234 op_sel:[1,1,0] op_sel_hi:[0,1,1] neg_hi:[1,0,0]
  v_pk_mul_f16 v231, v218, v202 op_sel:[0,0] op_sel_hi:[1,0]
  v_pk_mul_f16 v233, v219, v202 op_sel:[0,0] op_sel_hi:[1,0]
  ds_write_addtid_b32 v232 offset:12448
  ds_write_addtid_b32 v232 offset:12992
  ds_write_addtid_b32 v234 offset:13536
  ds_write_addtid_b32 v227 offset:16256
  ds_write_addtid_b32 v229 offset:16800
  v_pk_fma_f16 v225, v219, v194, v225 op_sel:[1,1,0] op_sel_hi:[0,1,1] neg_hi:[1,0,0]
  v_pk_mul_f16 v230, v229, v195 op_sel:[0,0] op_sel_hi:[1,0]
  v_pk_mul_f16 v224, v221, v198 op_sel:[0,0] op_sel_hi:[0,1]
  v_pk_mul_f16 v226, v222, v198 op_sel:[0,0] op_sel_hi:[0,1]
  v_pk_mul_f16 v228, v223, v198 op_sel:[0,0] op_sel_hi:[0,1]
  s_waitcnt lgkmcnt(8)
  buffer_store_dwordx4 a[236:239], v34, s[12:15], s67 offen sc1
  buffer_store_dwordx4 a[240:243], v34, s[12:15], s48 offen sc1
  ds_write_addtid_b32 v225 offset:15440
  ds_write_addtid_b32 v217 offset:11904
  ds_write_addtid_b32 v218 offset:14080
  v_pk_fma_f16 v230, v229, v195, v230 op_sel:[1,1,0] op_sel_hi:[0,1,1] neg_hi:[1,0,0]
  v_pk_fma_f16 v231, v218, v202, v231 op_sel:[1,1,0] op_sel_hi:[0,1,1] neg_hi:[1,0,0]
  v_pk_fma_f16 v233, v219, v202, v233 op_sel:[1,1,0] op_sel_hi:[0,1,1] neg_hi:[1,0,0]
  v_pk_fma_f16 v224, v221, v198, v224 op_sel:[1,1,0] op_sel_hi:[1,0,1] neg_lo:[1,0,0]
  v_pk_fma_f16 v226, v222, v198, v226 op_sel:[1,1,0] op_sel_hi:[1,0,1] neg_lo:[1,0,0]
  v_pk_fma_f16 v228, v223, v198, v228 op_sel:[1,1,0] op_sel_hi:[1,0,1] neg_lo:[1,0,0]
  v_pk_mul_f16 v235, v218, v194 op_sel:[0,0] op_sel_hi:[1,0]
  ds_write_addtid_b32 v219 offset:15168
  ds_write_addtid_b32 v230 offset:17072
  ds_write_addtid_b32 v231 offset:17344
  ds_write_addtid_b32 v233 offset:17888
  v_pk_mul_f16 v232, v231, v195 op_sel:[0,0] op_sel_hi:[1,0]
  v_pk_mul_f16 v234, v233, v195 op_sel:[0,0] op_sel_hi:[1,0]
  v_pk_mul_f16 v225, v224, v199 op_sel:[0,0] op_sel_hi:[0,1]
  v_pk_mul_f16 v227, v226, v199 op_sel:[0,0] op_sel_hi:[0,1]
  v_pk_mul_f16 v229, v228, v199 op_sel:[0,0] op_sel_hi:[0,1]
  v_pk_fma_f16 v235, v218, v194, v235 op_sel:[1,1,0] op_sel_hi:[0,1,1] neg_hi:[1,0,0]
  s_waitcnt vmcnt(15)
  s_barrier
  ds_read_b64_tr_b16 v[160:161], v10 offset:0
  ds_read_b64_tr_b16 v[162:163], v10 offset:1024
  ds_read_b128 v[168:171], v14 offset:0
  ds_read_b128 v[172:175], v14 offset:40960
  ds_read_b64_tr_b16 v[164:165], v11 offset:0
  ds_write_addtid_b32 v235 offset:14352
  v_pk_fma_f16 v232, v231, v195, v232 op_sel:[1,1,0] op_sel_hi:[0,1,1] neg_hi:[1,0,0]
  ds_read_b64_tr_b16 v[166:167], v11 offset:1024
  buffer_load_dwordx4 v2, s[4:7], s24 offen offset:0 lds
  buffer_load_dwordx4 v3, s[4:7], s24 offen offset:1024 lds
  buffer_load_dwordx4 v4, s[4:7], s24 offen offset:2048 lds
  ds_read_b128 a[224:227], v18 offset:0
  ds_read_b128 a[228:231], v19 offset:0
  v_pk_fma_f16 v234, v233, v195, v234 op_sel:[1,1,0] op_sel_hi:[0,1,1] neg_hi:[1,0,0]
  v_pk_fma_f16 v225, v224, v199, v225 op_sel:[1,1,0] op_sel_hi:[1,0,1] neg_lo:[1,0,0]
  v_pk_fma_f16 v227, v226, v199, v227 op_sel:[1,1,0] op_sel_hi:[1,0,1] neg_lo:[1,0,0]
  ds_write_addtid_b32 v232 offset:17616
  ds_write_addtid_b32 v234 offset:18160
  ds_read_b128 a[208:211], v25 offset:26112
  ds_read_b128 a[216:219], v25 offset:26144
  v_pk_fma_f16 v229, v228, v199, v229 op_sel:[1,1,0] op_sel_hi:[1,0,1] neg_lo:[1,0,0]
  v_pk_mul_f16 v217, v215, v211 op_sel:[0,0] op_sel_hi:[1,0]
  v_pk_fma_f16 v217, v215, v211, v217 op_sel:[1,1,0] op_sel_hi:[0,1,1] neg_hi:[1,0,0]
  v_pk_mul_f16 v230, v215, v203 op_sel:[0,0] op_sel_hi:[1,0]
  v_pk_mul_f16 v231, v215, v204 op_sel:[0,0] op_sel_hi:[1,0]
  v_pk_mul_f16 v218, v215, v212 op_sel:[0,0] op_sel_hi:[1,0]
  s_waitcnt vmcnt(14)
  ds_read_b128 v[176:179], v90 offset:40192
  ds_read_b128 v[184:187], v90 offset:40256
  ds_read_b128 v[180:183], v90 offset:40208
  ds_read_b128 v[188:191], v90 offset:40272
  ds_read_b64_tr_b16 a[244:245], v46 offset:34816
  ds_read_b64_tr_b16 a[246:247], v46 offset:35328
  ds_read_b64_tr_b16 a[248:249], v47 offset:34816
  ds_read_b64_tr_b16 a[250:251], v47 offset:35328
  ds_read_b128 a[40:43], v92 offset:39168
  buffer_load_dwordx4 v5, s[4:7], s24 offen offset:3072 lds
  s_add_u32 m0, s52, 20480
  v_pk_mul_f16 v237, v217, v204 op_sel:[0,0] op_sel_hi:[1,0]
  v_pk_fma_f16 v230, v215, v203, v230 op_sel:[1,1,0] op_sel_hi:[0,1,1] neg_hi:[1,0,0]
  v_pk_fma_f16 v231, v215, v204, v231 op_sel:[1,1,0] op_sel_hi:[0,1,1] neg_hi:[1,0,0]
  v_pk_fma_f16 v237, v217, v204, v237 op_sel:[1,1,0] op_sel_hi:[0,1,1] neg_hi:[1,0,0]
  v_pk_fma_f16 v218, v215, v212, v218 op_sel:[1,1,0] op_sel_hi:[0,1,1] neg_hi:[1,0,0]
  v_pk_mul_f16 v232, v230, v204 op_sel:[0,0] op_sel_hi:[1,0]
  v_pk_mul_f16 v233, v215, v205 op_sel:[0,0] op_sel_hi:[1,0]
  v_pk_mul_f16 v235, v231, v205 op_sel:[0,0] op_sel_hi:[1,0]
  v_pk_mul_f16 v219, v217, v212 op_sel:[0,0] op_sel_hi:[1,0]
  v_pk_mul_f16 v238, v217, v205 op_sel:[0,0] op_sel_hi:[1,0]
  ds_read_b128 a[44:47], v92 offset:39232
  ds_read_b128 a[48:51], v93 offset:39168
  ds_read_b128 a[52:55], v93 offset:39232
  buffer_load_dwordx4 v6, s[8:11], s25 offen offset:0 lds
  buffer_load_dwordx4 v7, s[8:11], s25 offen offset:1024 lds
  v_add_u32 v92, s24, v91
  v_add_u32 v93, s26, v91
  v_pk_mul_f16 v239, v237, v205 op_sel:[0,0] op_sel_hi:[1,0]
  v_pk_mul_f16 v241, v218, v205 op_sel:[0,0] op_sel_hi:[1,0]
  s_waitcnt lgkmcnt(11)
  ds_read_b128 a[56:59], v92 offset:39168
  ds_read_b128 a[60:63], v92 offset:39232
  v_lshlrev_b32 v128, 16, v176
  v_and_b32 v129, 0xffff0000, v176
  v_lshlrev_b32 v130, 16, v177
  v_and_b32 v131, 0xffff0000, v177
  v_lshlrev_b32 v132, 16, v178
  v_and_b32 v133, 0xffff0000, v178
  v_lshlrev_b32 v134, 16, v179
  s_waitcnt lgkmcnt(10)
  ds_read_b64_tr_b16 v[176:177], v10 offset:40960
  v_and_b32 v135, 0xffff0000, v179
  v_lshlrev_b32 v144, 16, v184
  v_and_b32 v145, 0xffff0000, v184
  v_lshlrev_b32 v146, 16, v185
  v_and_b32 v147, 0xffff0000, v185
  v_lshlrev_b32 v148, 16, v186
  v_and_b32 v149, 0xffff0000, v186
  v_lshlrev_b32 v150, 16, v187
  ds_read_b64_tr_b16 v[178:179], v10 offset:41984
  v_and_b32 v151, 0xffff0000, v187
  v_lshlrev_b32 v136, 16, v180
  v_and_b32 v137, 0xffff0000, v180
  v_lshlrev_b32 v138, 16, v181
  v_and_b32 v139, 0xffff0000, v181
  v_lshlrev_b32 v140, 16, v182
  v_and_b32 v141, 0xffff0000, v182
  v_lshlrev_b32 v142, 16, v183
  v_and_b32 v143, 0xffff0000, v183
  s_nop 1
  v_mfma_f32_32x32x16_bf16 v[64:79], v[160:163], v[168:171], v[128:143]
  ds_read_b128 v[184:187], v15 offset:0
  v_lshlrev_b32 v152, 16, v188
  v_and_b32 v153, 0xffff0000, v188
  v_lshlrev_b32 v154, 16, v189
  v_and_b32 v155, 0xffff0000, v189
  v_lshlrev_b32 v156, 16, v190
  v_and_b32 v157, 0xffff0000, v190
  v_lshlrev_b32 v158, 16, v191
  v_and_b32 v159, 0xffff0000, v191
  v_add_u32 v92, s28, v91
  ds_read_b128 a[64:67], v93 offset:39168
  ds_read_b128 a[68:71], v93 offset:39232
  ds_read_b128 a[72:75], v92 offset:39168
  ds_read_b128 a[76:79], v92 offset:39232
  ds_read_b128 v[188:191], v15 offset:40960
  v_add_u32 v93, s30, v91
  ds_read_b128 a[80:83], v93 offset:39168
  v_add_u32 v92, s36, v91
  ds_read_b128 a[84:87], v93 offset:39232
  ds_read_b128 a[88:91], v92 offset:39168
  ds_read_b128 a[92:95], v92 offset:39232
  buffer_load_dwordx4 v8, s[8:11], s25 offen offset:2048 lds
  buffer_load_dwordx4 v9, s[8:11], s25 offen offset:3072 lds
  s_add_u32 m0, s52, 0
  v_mfma_f32_32x32x16_bf16 v[80:95], v[160:163], v[172:175], v[128:143]
  s_waitcnt lgkmcnt(9)
  buffer_store_dwordx4 a[244:247], v45, s[12:15], 0 offen offset:0 sc1
  ds_read_b64_tr_b16 v[180:181], v11 offset:40960
  v_mfma_f32_32x32x16_bf16 v[96:111], v[164:167], v[168:171], v[144:159]
  s_lshl_b32 s25, s24, 6
  ds_read_b64_tr_b16 v[182:183], v11 offset:41984
  ds_read_b64_tr_b16 v[160:161], v12 offset:0
  ds_read_b64_tr_b16 v[162:163], v12 offset:1024
  ds_read_b128 v[168:171], v16 offset:0
  v_pk_mul_f16 v136, v195, v198 op_sel:[0,0] op_sel_hi:[0,1]
  v_pk_mul_f16 v138, v196, v198 op_sel:[0,0] op_sel_hi:[0,1]
  v_mfma_f32_32x32x16_bf16 v[112:127], v[164:167], v[172:175], v[144:159]
  s_add_u32 s25, s25, s64
  buffer_store_dwordx4 a[248:251], v45, s[12:15], 0 offen offset:1024 sc1
  ds_read_b128 v[172:175], v16 offset:40960
  v_mfma_f32_32x32x16_bf16 v[64:79], v[176:179], v[184:187], v[64:79]
  s_waitcnt lgkmcnt(10)
  ds_read_b64_tr_b16 v[164:165], v13 offset:0
  ds_read_b64_tr_b16 v[166:167], v13 offset:1024
  v_pk_mul_f16 v140, v220, v198 op_sel:[0,0] op_sel_hi:[0,1]
  v_pk_mul_f16 v142, v197, v198 op_sel:[0,0] op_sel_hi:[0,1]
  v_pk_fma_f16 v136, v195, v198, v136 op_sel:[1,1,0] op_sel_hi:[1,0,1] neg_lo:[1,0,0]
  v_pk_fma_f16 v138, v196, v198, v138 op_sel:[1,1,0] op_sel_hi:[1,0,1] neg_lo:[1,0,0]
  v_mfma_f32_32x32x16_bf16 v[80:95], v[176:179], v[188:191], v[80:95]
  s_lshl_b32 s24, s24, 5
  ds_read_b64_tr_b16 v[176:177], v12 offset:40960
  ds_read_b64_tr_b16 v[178:179], v12 offset:41984
  v_pk_fma_f16 v140, v220, v198, v140 op_sel:[1,1,0] op_sel_hi:[1,0,1] neg_lo:[1,0,0]
  v_pk_fma_f16 v142, v197, v198, v142 op_sel:[1,1,0] op_sel_hi:[1,0,1] neg_lo:[1,0,0]
  v_pk_mul_f16 v128, v195, v199 op_sel:[0,0] op_sel_hi:[0,1]
  v_pk_mul_f16 v129, v196, v199 op_sel:[0,0] op_sel_hi:[0,1]
  v_mfma_f32_16x16x32_bf16 a[232:235], a[40:43], a[224:227], 0
  s_waitcnt lgkmcnt(8)
  v_pk_mul_f16 v130, v220, v199 op_sel:[0,0] op_sel_hi:[0,1]
  v_pk_mul_f16 v131, v197, v199 op_sel:[0,0] op_sel_hi:[0,1]
  v_mfma_f32_32x32x16_bf16 v[96:111], v[180:183], v[184:187], v[96:111]
  s_add_u32 s24, s24, s35
  ds_read_b128 v[184:187], v17 offset:0
  v_pk_mul_f16 v132, v221, v199 op_sel:[0,0] op_sel_hi:[0,1]
  v_pk_mul_f16 v133, v222, v199 op_sel:[0,0] op_sel_hi:[0,1]
  v_pk_mul_f16 v134, v223, v199 op_sel:[0,0] op_sel_hi:[0,1]
  v_pk_mul_f16 v135, v198, v199 op_sel:[0,0] op_sel_hi:[0,1]
  v_pk_mul_f16 v137, v136, v199 op_sel:[0,0] op_sel_hi:[0,1]
  v_mfma_f32_32x32x16_bf16 v[112:127], v[180:183], v[188:191], v[112:127]
  s_waitcnt lgkmcnt(5)
  ds_read_b128 v[188:191], v17 offset:40960
  ds_read_b64_tr_b16 v[180:181], v13 offset:40960
  ds_read_b64_tr_b16 v[182:183], v13 offset:41984
  v_pk_mul_f16 v139, v138, v199 op_sel:[0,0] op_sel_hi:[0,1]
  v_pk_mul_f16 v141, v140, v199 op_sel:[0,0] op_sel_hi:[0,1]
  v_pk_mul_f16 v143, v142, v199 op_sel:[0,0] op_sel_hi:[0,1]
  v_mfma_f32_32x32x16_bf16 v[64:79], v[160:163], v[168:171], v[64:79]
  v_pk_fma_f16 v128, v195, v199, v128 op_sel:[1,1,0] op_sel_hi:[1,0,1] neg_lo:[1,0,0]
  v_pk_fma_f16 v129, v196, v199, v129 op_sel:[1,1,0] op_sel_hi:[1,0,1] neg_lo:[1,0,0]
  v_pk_fma_f16 v130, v220, v199, v130 op_sel:[1,1,0] op_sel_hi:[1,0,1] neg_lo:[1,0,0]
  v_pk_fma_f16 v131, v197, v199, v131 op_sel:[1,1,0] op_sel_hi:[1,0,1] neg_lo:[1,0,0]
  v_pk_fma_f16 v132, v221, v199, v132 op_sel:[1,1,0] op_sel_hi:[1,0,1] neg_lo:[1,0,0]
  v_pk_fma_f16 v133, v222, v199, v133 op_sel:[1,1,0] op_sel_hi:[1,0,1] neg_lo:[1,0,0]
  v_mfma_f32_32x32x16_bf16 v[80:95], v[160:163], v[172:175], v[80:95]
  v_pk_fma_f16 v134, v223, v199, v134 op_sel:[1,1,0] op_sel_hi:[1,0,1] neg_lo:[1,0,0]
  v_pk_fma_f16 v135, v198, v199, v135 op_sel:[1,1,0] op_sel_hi:[1,0,1] neg_lo:[1,0,0]
  v_pk_fma_f16 v137, v136, v199, v137 op_sel:[1,1,0] op_sel_hi:[1,0,1] neg_lo:[1,0,0]
  v_pk_fma_f16 v139, v138, v199, v139 op_sel:[1,1,0] op_sel_hi:[1,0,1] neg_lo:[1,0,0]
  v_pk_fma_f16 v141, v140, v199, v141 op_sel:[1,1,0] op_sel_hi:[1,0,1] neg_lo:[1,0,0]
  v_pk_fma_f16 v143, v142, v199, v143 op_sel:[1,1,0] op_sel_hi:[1,0,1] neg_lo:[1,0,0]
  v_mfma_f32_16x16x32_bf16 a[232:235], a[44:47], a[228:231], a[232:235]
  s_waitcnt lgkmcnt(3)
  ds_read_b128 a[240:243], v25 offset:26176
  ds_read_b128 a[248:251], v25 offset:26208
  v_mfma_f32_32x32x16_bf16 v[96:111], v[164:167], v[168:171], v[96:111]
  v_pk_fma_f16 v232, v230, v204, v232 op_sel:[1,1,0] op_sel_hi:[0,1,1] neg_hi:[1,0,0]
  v_pk_fma_f16 v233, v215, v205, v233 op_sel:[1,1,0] op_sel_hi:[0,1,1] neg_hi:[1,0,0]
  v_pk_fma_f16 v235, v231, v205, v235 op_sel:[1,1,0] op_sel_hi:[0,1,1] neg_hi:[1,0,0]
  v_pk_fma_f16 v239, v237, v205, v239 op_sel:[1,1,0] op_sel_hi:[0,1,1] neg_hi:[1,0,0]
  v_pk_fma_f16 v241, v218, v205, v241 op_sel:[1,1,0] op_sel_hi:[0,1,1] neg_hi:[1,0,0]
  v_pk_mul_f16 v234, v230, v205 op_sel:[0,0] op_sel_hi:[1,0]
  v_mfma_f32_32x32x16_bf16 v[112:127], v[164:167], v[172:175], v[112:127]
  s_waitcnt vmcnt(12) lgkmcnt(2)
  s_barrier
  ds_read_b64_tr_b16 v[160:161], v10 offset:8192
  ds_read_b64_tr_b16 v[162:163], v10 offset:9216
  ds_read_b128 v[168:171], v14 offset:8192
  ds_read_b128 v[172:175], v14 offset:49152
  v_mfma_f32_32x32x16_bf16 v[64:79], v[176:179], v[184:187], v[64:79]
  ds_read_b64_tr_b16 v[164:165], v11 offset:8192
  ds_read_b64_tr_b16 v[166:167], v11 offset:9216
  buffer_load_dwordx4 v2, s[4:7], s26 offen offset:0 lds
  buffer_load_dwordx4 v3, s[4:7], s26 offen offset:1024 lds
  buffer_load_dwordx4 v4, s[4:7], s26 offen offset:2048 lds
  ds_read_b128 a[224:227], v18 offset:8192
  v_mfma_f32_32x32x16_bf16 v[80:95], v[176:179], v[188:191], v[80:95]
  ds_read_b64_tr_b16 v[176:177], v10 offset:49152
  ds_read_b64_tr_b16 v[178:179], v10 offset:50176
  ds_read_b128 a[228:231], v19 offset:8192
  v_pk_mul_f16 v236, v232, v205 op_sel:[0,0] op_sel_hi:[1,0]
  v_pk_mul_f16 v240, v217, v206 op_sel:[0,0] op_sel_hi:[1,0]
  v_pk_fma_f16 v219, v217, v212, v219 op_sel:[1,1,0] op_sel_hi:[0,1,1] neg_hi:[1,0,0]
  v_mfma_f32_32x32x16_bf16 v[96:111], v[180:183], v[184:187], v[96:111]
  ds_read_b128 v[184:187], v15 offset:8192
  v_pk_mul_f16 v242, v218, v206 op_sel:[0,0] op_sel_hi:[1,0]
  v_pk_fma_f16 v234, v230, v205, v234 op_sel:[1,1,0] op_sel_hi:[0,1,1] neg_hi:[1,0,0]
  v_pk_fma_f16 v236, v232, v205, v236 op_sel:[1,1,0] op_sel_hi:[0,1,1] neg_hi:[1,0,0]
  v_pk_fma_f16 v238, v217, v205, v238 op_sel:[1,1,0] op_sel_hi:[0,1,1] neg_hi:[1,0,0]
  v_pk_fma_f16 v240, v217, v206, v240 op_sel:[1,1,0] op_sel_hi:[0,1,1] neg_hi:[1,0,0]
  v_mfma_f32_32x32x16_bf16 v[112:127], v[180:183], v[188:191], v[112:127]
  s_waitcnt lgkmcnt(8)
  ds_read_b128 v[188:191], v15 offset:49152
  buffer_load_dwordx4 v5, s[4:7], s26 offen offset:3072 lds
  s_add_u32 m0, s52, 4096
  ds_read_b64_tr_b16 v[180:181], v11 offset:49152
  ds_read_b64_tr_b16 v[182:183], v11 offset:50176
  v_pk_fma_f16 v242, v218, v206, v242 op_sel:[1,1,0] op_sel_hi:[0,1,1] neg_hi:[1,0,0]
  v_mfma_f32_32x32x16_bf16 v[64:79], v[160:163], v[168:171], v[64:79]
  s_waitcnt lgkmcnt(8)
  buffer_load_dwordx4 v6, s[8:11], s27 offen offset:0 lds
  v_pk_mul_f16 v245, v215, v213 op_sel:[0,0] op_sel_hi:[1,0]
  v_pk_mul_f16 v247, v217, v213 op_sel:[0,0] op_sel_hi:[1,0]
  v_pk_mul_f16 v249, v218, v213 op_sel:[0,0] op_sel_hi:[1,0]
  v_pk_mul_f16 v251, v219, v213 op_sel:[0,0] op_sel_hi:[1,0]
  v_pk_fma_f16 v245, v215, v213, v245 op_sel:[1,1,0] op_sel_hi:[0,1,1] neg_hi:[1,0,0]
  v_mfma_f32_32x32x16_bf16 v[80:95], v[160:163], v[172:175], v[80:95]
  ds_read_b64_tr_b16 v[160:161], v12 offset:8192
  ds_read_b64_tr_b16 v[162:163], v12 offset:9216
  v_pk_fma_f16 v247, v217, v213, v247 op_sel:[1,1,0] op_sel_hi:[0,1,1] neg_hi:[1,0,0]
  v_pk_fma_f16 v249, v218, v213, v249 op_sel:[1,1,0] op_sel_hi:[0,1,1] neg_hi:[1,0,0]
  v_pk_fma_f16 v251, v219, v213, v251 op_sel:[1,1,0] op_sel_hi:[0,1,1] neg_hi:[1,0,0]
  v_pk_mul_f16 v243, v219, v205 op_sel:[0,0] op_sel_hi:[1,0]
  v_mfma_f32_32x32x16_bf16 v[96:111], v[164:167], v[168:171], v[96:111]
  buffer_load_dwordx4 v7, s[8:11], s27 offen offset:1024 lds
  ds_read_b128 v[168:171], v16 offset:8192
  v_pk_mul_f16 v244, v219, v206 op_sel:[0,0] op_sel_hi:[1,0]
  v_pk_mul_f16 v246, v245, v206 op_sel:[0,0] op_sel_hi:[1,0]
  v_pk_mul_f16 v248, v247, v206 op_sel:[0,0] op_sel_hi:[1,0]
  v_pk_mul_f16 v250, v249, v206 op_sel:[0,0] op_sel_hi:[1,0]
  v_mfma_f32_32x32x16_bf16 v[112:127], v[164:167], v[172:175], v[112:127]
  s_waitcnt lgkmcnt(3)
  ds_read_b128 v[172:175], v16 offset:49152
  ds_read_b64_tr_b16 v[164:165], v13 offset:8192
  ds_read_b64_tr_b16 v[166:167], v13 offset:9216
  v_pk_mul_f16 v252, v251, v206 op_sel:[0,0] op_sel_hi:[1,0]
  v_pk_mul_f16 v253, v206, v210 op_sel:[0,0] op_sel_hi:[0,1]
  v_pk_mul_f16 v254, v207, v210 op_sel:[0,0] op_sel_hi:[0,1]
  v_mfma_f32_32x32x16_bf16 v[64:79], v[176:179], v[184:187], v[64:79]
  buffer_load_dwordx4 v8, s[8:11], s27 offen offset:2048 lds
  v_pk_fma_f16 v243, v219, v205, v243 op_sel:[1,1,0] op_sel_hi:[0,1,1] neg_hi:[1,0,0]
  v_pk_fma_f16 v244, v219, v206, v244 op_sel:[1,1,0] op_sel_hi:[0,1,1] neg_hi:[1,0,0]
  v_pk_fma_f16 v246, v245, v206, v246 op_sel:[1,1,0] op_sel_hi:[0,1,1] neg_hi:[1,0,0]
  v_pk_fma_f16 v248, v247, v206, v248 op_sel:[1,1,0] op_sel_hi:[0,1,1] neg_hi:[1,0,0]
  v_pk_fma_f16 v250, v249, v206, v250 op_sel:[1,1,0] op_sel_hi:[0,1,1] neg_hi:[1,0,0]
  v_mfma_f32_32x32x16_bf16 v[80:95], v[176:179], v[188:191], v[80:95]
  ds_read_b64_tr_b16 v[176:177], v12 offset:49152
  ds_read_b64_tr_b16 v[178:179], v12 offset:50176
  v_pk_fma_f16 v252, v251, v206, v252 op_sel:[1,1,0] op_sel_hi:[0,1,1] neg_hi:[1,0,0]
  v_pk_fma_f16 v253, v206, v210, v253 op_sel:[1,1,0] op_sel_hi:[1,0,1] neg_lo:[1,0,0]
  v_pk_fma_f16 v254, v207, v210, v254 op_sel:[1,1,0] op_sel_hi:[1,0,1] neg_lo:[1,0,0]
  v_mfma_f32_16x16x32_bf16 a[232:235], a[48:51], a[224:227], a[232:235]
  buffer_load_dwordx4 v9, s[8:11], s27 offen offset:3072 lds
  s_add_u32 m0, s52, 8192
  v_mfma_f32_32x32x16_bf16 v[96:111], v[180:183], v[184:187], v[96:111]
  s_lshl_b32 s27, s26, 6
  ds_read_b128 v[184:187], v17 offset:8192
  s_add_u32 s27, s27, s64
  s_lshl_b32 s26, s26, 5
  s_add_u32 s26, s26, s35
  v_mfma_f32_32x32x16_bf16 v[112:127], v[180:183], v[188:191], v[112:127]
  s_waitcnt lgkmcnt(3)
  ds_read_b128 v[188:191], v17 offset:49152
  ds_read_b64_tr_b16 v[180:181], v13 offset:49152
  ds_read_b64_tr_b16 v[182:183], v13 offset:50176
  v_mfma_f32_32x32x16_bf16 v[64:79], v[160:163], v[168:171], v[64:79]
  v_mfma_f32_32x32x16_bf16 v[80:95], v[160:163], v[172:175], v[80:95]
  v_mfma_f32_16x16x32_bf16 a[232:235], a[52:55], a[228:231], a[232:235]
  v_mfma_f32_32x32x16_bf16 v[96:111], v[164:167], v[168:171], v[96:111]
  v_mfma_f32_32x32x16_bf16 v[112:127], v[164:167], v[172:175], v[112:127]
  s_waitcnt vmcnt(10) lgkmcnt(0)
  s_barrier
  ds_read_b64_tr_b16 v[160:161], v10 offset:16384
  ds_read_b64_tr_b16 v[162:163], v10 offset:17408
  ds_read_b128 v[168:171], v14 offset:16384
  ds_read_b128 v[172:175], v14 offset:57344
  v_mfma_f32_32x32x16_bf16 v[64:79], v[176:179], v[184:187], v[64:79]
  s_waitcnt vmcnt(8)
  s_mov_b64 exec, 1
  buffer_store_dwordx2 v[40:41], off, s[12:15], s62 sc1
  s_mov_b64 exec, -1
  ds_read_b64_tr_b16 v[164:165], v11 offset:16384
  ds_read_b64_tr_b16 v[166:167], v11 offset:17408
  v_mfma_f32_32x32x16_bf16 v[80:95], v[176:179], v[188:191], v[80:95]
  ds_read_b64_tr_b16 v[176:177], v10 offset:57344
  ds_read_b64_tr_b16 v[178:179], v10 offset:58368
  buffer_load_dwordx4 v2, s[4:7], s28 offen offset:0 lds
  buffer_load_dwordx4 v3, s[4:7], s28 offen offset:1024 lds
  buffer_load_dwordx4 v4, s[4:7], s28 offen offset:2048 lds
  ds_read_b128 a[224:227], v18 offset:16384
  v_mfma_f32_32x32x16_bf16 v[96:111], v[180:183], v[184:187], v[96:111]
  ds_read_b128 v[184:187], v15 offset:16384
  ds_read_b128 a[228:231], v19 offset:16384
  v_mfma_f32_32x32x16_bf16 v[112:127], v[180:183], v[188:191], v[112:127]
  s_waitcnt lgkmcnt(8)
  ds_read_b128 v[188:191], v15 offset:57344
  buffer_load_dwordx4 v5, s[4:7], s28 offen offset:3072 lds
  s_add_u32 m0, s52, 12288
  ds_read_b64_tr_b16 v[180:181], v11 offset:57344
  ds_read_b64_tr_b16 v[182:183], v11 offset:58368
  v_mfma_f32_32x32x16_bf16 v[64:79], v[160:163], v[168:171], v[64:79]
  s_waitcnt lgkmcnt(9)
  v_mfma_f32_32x32x16_bf16 v[80:95], v[160:163], v[172:175], v[80:95]
  s_waitcnt lgkmcnt(6)
  ds_read_b64_tr_b16 v[160:161], v12 offset:16384
  buffer_load_dwordx4 v6, s[8:11], s29 offen offset:0 lds
  ds_read_b64_tr_b16 v[162:163], v12 offset:17408
  v_mfma_f32_32x32x16_bf16 v[96:111], v[164:167], v[168:171], v[96:111]
  ds_read_b128 v[168:171], v16 offset:16384
  v_mfma_f32_32x32x16_bf16 v[112:127], v[164:167], v[172:175], v[112:127]
  s_waitcnt lgkmcnt(4)
  ds_read_b128 v[172:175], v16 offset:57344
  buffer_load_dwordx4 v7, s[8:11], s29 offen offset:1024 lds
  ds_read_b64_tr_b16 v[164:165], v13 offset:16384
  ds_read_b64_tr_b16 v[166:167], v13 offset:17408
  v_mfma_f32_32x32x16_bf16 v[64:79], v[176:179], v[184:187], v[64:79]
  v_mfma_f32_32x32x16_bf16 v[80:95], v[176:179], v[188:191], v[80:95]
  ds_read_b64_tr_b16 v[176:177], v12 offset:57344
  buffer_load_dwordx4 v8, s[8:11], s29 offen offset:2048 lds
  ds_read_b64_tr_b16 v[178:179], v12 offset:58368
  v_mfma_f32_16x16x32_bf16 a[232:235], a[56:59], a[224:227], a[232:235]
  s_waitcnt lgkmcnt(5)
  v_mfma_f32_32x32x16_bf16 v[96:111], v[180:183], v[184:187], v[96:111]
  ds_read_b128 v[184:187], v17 offset:16384
  v_mfma_f32_32x32x16_bf16 v[112:127], v[180:183], v[188:191], v[112:127]
  buffer_load_dwordx4 v9, s[8:11], s29 offen offset:3072 lds
  ds_read_b128 v[188:191], v17 offset:57344
  ds_read_b64_tr_b16 v[180:181], v13 offset:57344
  ds_read_b64_tr_b16 v[182:183], v13 offset:58368
  s_add_u32 m0, s52, 16384
  s_lshl_b32 s29, s28, 6
  v_mfma_f32_32x32x16_bf16 v[64:79], v[160:163], v[168:171], v[64:79]
  s_waitcnt lgkmcnt(4)
  s_add_u32 s29, s29, s64
  s_lshl_b32 s28, s28, 5
  s_add_u32 s28, s28, s35
  v_mfma_f32_32x32x16_bf16 v[80:95], v[160:163], v[172:175], v[80:95]
  v_mfma_f32_16x16x32_bf16 a[232:235], a[60:63], a[228:231], a[232:235]
  v_mfma_f32_32x32x16_bf16 v[96:111], v[164:167], v[168:171], v[96:111]
  v_mfma_f32_32x32x16_bf16 v[112:127], v[164:167], v[172:175], v[112:127]
  s_waitcnt vmcnt(9) lgkmcnt(0)
  s_barrier
  ds_read_b64_tr_b16 v[160:161], v10 offset:0
  ds_read_b64_tr_b16 v[162:163], v10 offset:1024
  ds_read_b128 v[168:171], v14 offset:0
  ds_read_b128 v[172:175], v14 offset:40960
  v_mfma_f32_32x32x16_bf16 v[64:79], v[176:179], v[184:187], v[64:79]
  ds_read_b64_tr_b16 v[164:165], v11 offset:0
  ds_read_b64_tr_b16 v[166:167], v11 offset:1024
  buffer_load_dwordx4 v2, s[4:7], s30 offen offset:0 lds
  buffer_load_dwordx4 v3, s[4:7], s30 offen offset:1024 lds
  buffer_load_dwordx4 v4, s[4:7], s30 offen offset:2048 lds
  ds_read_b128 a[224:227], v18 offset:0
  v_mfma_f32_32x32x16_bf16 v[80:95], v[176:179], v[188:191], v[80:95]
  ds_read_b64_tr_b16 v[176:177], v10 offset:40960
  ds_read_b64_tr_b16 v[178:179], v10 offset:41984
  ds_read_b128 a[228:231], v19 offset:0
  v_mfma_f32_32x32x16_bf16 v[96:111], v[180:183], v[184:187], v[96:111]
  ds_read_b128 v[184:187], v15 offset:0
  v_mfma_f32_32x32x16_bf16 v[112:127], v[180:183], v[188:191], v[112:127]
  s_waitcnt lgkmcnt(8)
  ds_read_b128 v[188:191], v15 offset:40960
  buffer_load_dwordx4 v5, s[4:7], s30 offen offset:3072 lds
  s_add_u32 m0, s52, 20480
  ds_read_b64_tr_b16 v[180:181], v11 offset:40960
  ds_read_b64_tr_b16 v[182:183], v11 offset:41984
  v_mfma_f32_32x32x16_bf16 v[64:79], v[160:163], v[168:171], v[64:79]
  s_waitcnt lgkmcnt(9)
  v_mfma_f32_32x32x16_bf16 v[80:95], v[160:163], v[172:175], v[80:95]
  s_waitcnt lgkmcnt(6)
  buffer_load_dwordx4 v6, s[8:11], s31 offen offset:0 lds
  ds_read_b64_tr_b16 v[160:161], v12 offset:0
  ds_read_b64_tr_b16 v[162:163], v12 offset:1024
  v_mfma_f32_32x32x16_bf16 v[96:111], v[164:167], v[168:171], v[96:111]
  ds_read_b128 v[168:171], v16 offset:0
  buffer_load_dwordx4 v7, s[8:11], s31 offen offset:1024 lds
  v_mfma_f32_32x32x16_bf16 v[112:127], v[164:167], v[172:175], v[112:127]
  s_waitcnt lgkmcnt(4)
  ds_read_b128 v[172:175], v16 offset:40960
  ds_read_b64_tr_b16 v[164:165], v13 offset:0
  ds_read_b64_tr_b16 v[166:167], v13 offset:1024
  v_mfma_f32_32x32x16_bf16 v[64:79], v[176:179], v[184:187], v[64:79]
  v_mfma_f32_32x32x16_bf16 v[80:95], v[176:179], v[188:191], v[80:95]
  buffer_load_dwordx4 v8, s[8:11], s31 offen offset:2048 lds
  ds_read_b64_tr_b16 v[176:177], v12 offset:40960
  ds_read_b64_tr_b16 v[178:179], v12 offset:41984
  v_mfma_f32_16x16x32_bf16 a[232:235], a[64:67], a[224:227], a[232:235]
  s_waitcnt lgkmcnt(5)
  v_mfma_f32_32x32x16_bf16 v[96:111], v[180:183], v[184:187], v[96:111]
  buffer_load_dwordx4 v9, s[8:11], s31 offen offset:3072 lds
  ds_read_b128 v[184:187], v17 offset:0
  s_add_u32 m0, s52, 0
  s_lshl_b32 s31, s30, 6
  s_lshl_b32 s30, s30, 5
  s_add_u32 s30, s30, s35
  v_mfma_f32_32x32x16_bf16 v[112:127], v[180:183], v[188:191], v[112:127]
  s_add_u32 s31, s31, s64
  ds_read_b128 v[188:191], v17 offset:40960
  ds_read_b64_tr_b16 v[180:181], v13 offset:40960
  ds_read_b64_tr_b16 v[182:183], v13 offset:41984
  v_mfma_f32_32x32x16_bf16 v[64:79], v[160:163], v[168:171], v[64:79]
  s_waitcnt lgkmcnt(5)
  buffer_load_dword v36, v44, s[12:15], s66 offen sc1
  v_mfma_f32_32x32x16_bf16 v[80:95], v[160:163], v[172:175], v[80:95]
  v_mfma_f32_16x16x32_bf16 a[232:235], a[68:71], a[228:231], a[232:235]
  v_mfma_f32_32x32x16_bf16 v[96:111], v[164:167], v[168:171], v[96:111]
  v_mfma_f32_32x32x16_bf16 v[112:127], v[164:167], v[172:175], v[112:127]
  s_waitcnt vmcnt(9) lgkmcnt(0)
  s_barrier
  ds_read_b64_tr_b16 v[160:161], v10 offset:8192
  ds_read_b64_tr_b16 v[162:163], v10 offset:9216
  ds_read_b128 v[168:171], v14 offset:8192
  ds_read_b128 v[172:175], v14 offset:49152
  v_mfma_f32_32x32x16_bf16 v[64:79], v[176:179], v[184:187], v[64:79]
  ds_read_b64_tr_b16 v[164:165], v11 offset:8192
  ds_read_b64_tr_b16 v[166:167], v11 offset:9216
  buffer_load_dwordx4 v2, s[4:7], s36 offen offset:0 lds
  buffer_load_dwordx4 v3, s[4:7], s36 offen offset:1024 lds
  buffer_load_dwordx4 v4, s[4:7], s36 offen offset:2048 lds
  ds_read_b128 a[224:227], v18 offset:8192
  v_mfma_f32_32x32x16_bf16 v[80:95], v[176:179], v[188:191], v[80:95]
  ds_read_b64_tr_b16 v[176:177], v10 offset:49152
  ds_read_b64_tr_b16 v[178:179], v10 offset:50176
  ds_read_b128 a[228:231], v19 offset:8192
  v_mfma_f32_32x32x16_bf16 v[96:111], v[180:183], v[184:187], v[96:111]
  ds_read_b128 v[184:187], v15 offset:8192
  v_mfma_f32_32x32x16_bf16 v[112:127], v[180:183], v[188:191], v[112:127]
  s_waitcnt lgkmcnt(8)
  ds_read_b128 v[188:191], v15 offset:49152
  buffer_load_dwordx4 v5, s[4:7], s36 offen offset:3072 lds
  s_add_u32 m0, s52, 4096
  ds_read_b64_tr_b16 v[180:181], v11 offset:49152
  ds_read_b64_tr_b16 v[182:183], v11 offset:50176
  v_mfma_f32_32x32x16_bf16 v[64:79], v[160:163], v[168:171], v[64:79]
  s_waitcnt lgkmcnt(9)
  s_lshl_b32 s51, s50, 6
  buffer_load_dwordx4 v6, s[8:11], s37 offen offset:0 lds
  s_add_u32 s51, s51, s64
  s_lshl_b32 s50, s50, 5
  s_add_u32 s50, s50, s35
  s_add_u32 s38, s50, 114688
  v_mfma_f32_32x32x16_bf16 v[80:95], v[160:163], v[172:175], v[80:95]
  s_waitcnt lgkmcnt(6)
  ds_read_b64_tr_b16 v[160:161], v12 offset:8192
  ds_read_b64_tr_b16 v[162:163], v12 offset:9216
  v_mfma_f32_32x32x16_bf16 v[96:111], v[164:167], v[168:171], v[96:111]
  ds_read_b128 v[168:171], v16 offset:8192
  buffer_load_dwordx4 v7, s[8:11], s37 offen offset:1024 lds
  v_mfma_f32_32x32x16_bf16 v[112:127], v[164:167], v[172:175], v[112:127]
  s_waitcnt lgkmcnt(4)
  ds_read_b128 v[172:175], v16 offset:49152
  ds_read_b64_tr_b16 v[164:165], v13 offset:8192
  ds_read_b64_tr_b16 v[166:167], v13 offset:9216
  v_mfma_f32_32x32x16_bf16 v[64:79], v[176:179], v[184:187], v[64:79]
  v_mfma_f32_32x32x16_bf16 v[80:95], v[176:179], v[188:191], v[80:95]
  buffer_load_dwordx4 v8, s[8:11], s37 offen offset:2048 lds
  ds_read_b64_tr_b16 v[176:177], v12 offset:49152
  ds_read_b64_tr_b16 v[178:179], v12 offset:50176
  v_mfma_f32_16x16x32_bf16 a[232:235], a[72:75], a[224:227], a[232:235]
  s_waitcnt lgkmcnt(5)
  v_mfma_f32_32x32x16_bf16 v[96:111], v[180:183], v[184:187], v[96:111]
  buffer_load_dwordx4 v9, s[8:11], s37 offen offset:3072 lds
  ds_read_b128 v[184:187], v17 offset:8192
  s_add_u32 m0, s52, 0
  s_lshl_b32 s37, s36, 6
  ds_write_addtid_b32 v248 offset:24752
  ds_write_addtid_b32 v249 offset:25024
  v_mfma_f32_32x32x16_bf16 v[112:127], v[180:183], v[188:191], v[112:127]
  s_lshl_b32 s36, s36, 5
  ds_read_b128 v[188:191], v17 offset:49152
  ds_read_b64_tr_b16 v[180:181], v13 offset:49152
  ds_read_b64_tr_b16 v[182:183], v13 offset:50176
  ds_write_addtid_b32 v250 offset:25296
  ds_write_addtid_b32 v251 offset:25568
  ds_write_addtid_b32 v252 offset:25840
  v_mfma_f32_32x32x16_bf16 v[64:79], v[160:163], v[168:171], v[64:79]
  s_waitcnt lgkmcnt(10)
  s_add_u32 s36, s36, s35
  s_add_u32 s37, s37, s64
  v_mfma_f32_32x32x16_bf16 v[80:95], v[160:163], v[172:175], v[80:95]
  v_mfma_f32_16x16x32_bf16 a[232:235], a[76:79], a[228:231], a[232:235]
  v_mfma_f32_32x32x16_bf16 v[96:111], v[164:167], v[168:171], v[96:111]
  s_waitcnt vmcnt(8)
  v_cmp_ne_u32 vcc, s61, v36
  s_cbranch_vccnz Lspin_w
Lok_w:
  buffer_load_dwordx2 v[36:37], v33, s[12:15], s66 offen sc1
  v_mfma_f32_32x32x16_bf16 v[112:127], v[164:167], v[172:175], v[112:127]
  s_waitcnt lgkmcnt(2)
  buffer_load_dwordx4 a[0:3], v38, s[12:15], s51 offen offset:0 sc1
  buffer_load_dwordx4 a[4:7], v38, s[12:15], s51 offen offset:1024 sc1
  s_barrier
  ds_read_b64_tr_b16 v[160:161], v10 offset:16384
  ds_read_b64_tr_b16 v[162:163], v10 offset:17408
  v_mfma_f32_32x32x16_bf16 v[64:79], v[176:179], v[184:187], v[64:79]
  ds_read_b128 v[168:171], v14 offset:16384
  buffer_load_dwordx4 a[8:11], v38, s[12:15], s51 offen offset:2048 sc1
  ds_read_b128 v[172:175], v14 offset:57344
  ds_read_b64_tr_b16 v[164:165], v11 offset:16384
  ds_read_b64_tr_b16 v[166:167], v11 offset:17408
  ds_read_b128 a[224:227], v18 offset:16384
  v_mfma_f32_32x32x16_bf16 v[80:95], v[176:179], v[188:191], v[80:95]
  ds_read_b64_tr_b16 v[176:177], v10 offset:57344
  ds_read_b64_tr_b16 v[178:179], v10 offset:58368
  ds_read_b128 a[228:231], v19 offset:16384
  v_mfma_f32_32x32x16_bf16 v[96:111], v[180:183], v[184:187], v[96:111]
  ds_read_b128 v[184:187], v15 offset:16384
  buffer_load_dwordx4 a[12:15], v38, s[12:15], s51 offen offset:3072 sc1
  s_add_u32 s51, s51, 4096
  ds_write_addtid_b32 v216 offset:8704
  ds_write_addtid_b32 v195 offset:8976
  ds_write_addtid_b32 v196 offset:9248
  v_mfma_f32_32x32x16_bf16 v[112:127], v[180:183], v[188:191], v[112:127]
  ds_read_b128 v[188:191], v15 offset:57344
  s_waitcnt lgkmcnt(12)
  v_mfma_f32_32x32x16_bf16 v[64:79], v[160:163], v[168:171], v[64:79]
  s_waitcnt lgkmcnt(11)
  ds_read_b64_tr_b16 v[180:181], v11 offset:57344
  ds_read_b64_tr_b16 v[182:183], v11 offset:58368
  buffer_load_dwordx4 a[16:19], v38, s[12:15], s51 offen offset:0 sc1
  ds_write_addtid_b32 v197 offset:9792
  ds_write_addtid_b32 v198 offset:10880
  ds_write_addtid_b32 v199 offset:13056
  v_mfma_f32_32x32x16_bf16 v[80:95], v[160:163], v[172:175], v[80:95]
  s_waitcnt lgkmcnt(13)
  ds_read_b64_tr_b16 v[160:161], v12 offset:16384
  ds_read_b64_tr_b16 v[162:163], v12 offset:17408
  ds_write_addtid_b32 v128 offset:13328
  v_mfma_f32_32x32x16_bf16 v[96:111], v[164:167], v[168:171], v[96:111]
  ds_read_b128 v[168:171], v16 offset:16384
  buffer_load_dwordx4 a[20:23], v38, s[12:15], s51 offen offset:1024 sc1
  ds_write_addtid_b32 v129 offset:13600
  v_mfma_f32_32x32x16_bf16 v[112:127], v[164:167], v[172:175], v[112:127]
  s_waitcnt lgkmcnt(12)
  ds_read_b128 v[172:175], v16 offset:57344
  ds_read_b64_tr_b16 v[164:165], v13 offset:16384
  ds_read_b64_tr_b16 v[166:167], v13 offset:17408
  ds_write_addtid_b32 v220 offset:9520
  v_pk_mul_f16 v220, v206, v207 op_sel:[0,0] op_sel_hi:[0,1]
  v_pk_fma_f16 v220, v206, v207, v220 op_sel:[1,1,0] op_sel_hi:[1,0,1] neg_lo:[1,0,0]
  v_mfma_f32_32x32x16_bf16 v[64:79], v[176:179], v[184:187], v[64:79]
  s_waitcnt lgkmcnt(13)
  s_lshl_b32 s1, s0, 6
  buffer_load_dwordx4 a[24:27], v38, s[12:15], s51 offen offset:2048 sc1
  s_add_u32 s1, s1, s64
  ds_write_addtid_b32 v130 offset:13872
  ds_write_addtid_b32 v131 offset:14144
  ds_write_addtid_b32 v221 offset:10064
  v_mfma_f32_32x32x16_bf16 v[80:95], v[176:179], v[188:191], v[80:95]
  s_lshl_b32 s0, s0, 5
  ds_read_b64_tr_b16 v[176:177], v12 offset:57344
  ds_read_b64_tr_b16 v[178:179], v12 offset:58368
  ds_write_addtid_b32 v132 offset:14416
  ds_write_addtid_b32 v222 offset:10336
  ds_write_addtid_b32 v133 offset:14688
  s_add_u32 s0, s0, s35
  v_mfma_f32_16x16x32_bf16 a[232:235], a[80:83], a[224:227], a[232:235]
  s_waitcnt lgkmcnt(14)
  ds_write_addtid_b32 v223 offset:10608
  buffer_load_dwordx4 a[28:31], v38, s[12:15], s51 offen offset:3072 sc1
  v_mfma_f32_32x32x16_bf16 v[96:111], v[180:183], v[184:187], v[96:111]
  ds_read_b128 v[184:187], v17 offset:16384
  ds_write_addtid_b32 v134 offset:14960
  v_pk_mul_f16 v221, v206, v208 op_sel:[0,0] op_sel_hi:[0,1]
  v_pk_mul_f16 v222, v207, v208 op_sel:[0,0] op_sel_hi:[0,1]
  v_pk_mul_f16 v223, v220, v208 op_sel:[0,0] op_sel_hi:[0,1]
  v_pk_fma_f16 v221, v206, v208, v221 op_sel:[1,1,0] op_sel_hi:[1,0,1] neg_lo:[1,0,0]
  v_mfma_f32_32x32x16_bf16 v[112:127], v[180:183], v[188:191], v[112:127]
  s_waitcnt lgkmcnt(12)
  ds_read_b128 v[188:191], v17 offset:57344
  ds_read_b64_tr_b16 v[180:181], v13 offset:57344
  ds_read_b64_tr_b16 v[182:183], v13 offset:58368
  ds_write_addtid_b32 v135 offset:15232
  ds_write_addtid_b32 v136 offset:11152
  buffer_load_dwordx4 a[32:35], v38, s[12:15], s1 offen offset:0 sc1
  v_mfma_f32_32x32x16_bf16 v[64:79], v[160:163], v[168:171], v[64:79]
  ds_write_addtid_b32 v137 offset:15504
  ds_write_addtid_b32 v138 offset:11424
  ds_write_addtid_b32 v139 offset:15776
  v_pk_fma_f16 v222, v207, v208, v222 op_sel:[1,1,0] op_sel_hi:[1,0,1] neg_lo:[1,0,0]
  v_pk_fma_f16 v223, v220, v208, v223 op_sel:[1,1,0] op_sel_hi:[1,0,1] neg_lo:[1,0,0]
  v_pk_mul_f16 v255, v220, v210 op_sel:[0,0] op_sel_hi:[0,1]
  v_mfma_f32_32x32x16_bf16 v[80:95], v[160:163], v[172:175], v[80:95]
  ds_write_addtid_b32 v140 offset:11696
  ds_write_addtid_b32 v141 offset:16048
  ds_write_addtid_b32 v142 offset:11968
  ds_write_addtid_b32 v224 offset:12240
  ds_write_addtid_b32 v226 offset:12512
  buffer_load_dwordx4 a[36:39], v38, s[12:15], s1 offen offset:1024 sc1
  v_mfma_f32_16x16x32_bf16 a[232:235], a[84:87], a[228:231], a[232:235]
  ds_write_addtid_b32 v228 offset:12784
  v_pk_mul_f16 v224, v208, v210 op_sel:[0,0] op_sel_hi:[0,1]
  v_mfma_f32_32x32x16_bf16 v[96:111], v[164:167], v[168:171], v[96:111]
  s_waitcnt vmcnt(10)
  v_cmp_ne_u32 vcc, s61, v36
  s_cbranch_vccnz Lspin_u
Lok_u:
  v_pk_mul_f16 v226, v222, v210 op_sel:[0,0] op_sel_hi:[0,1]
  v_pk_mul_f16 v228, v209, v210 op_sel:[0,0] op_sel_hi:[0,1]
  v_pk_fma_f16 v255, v220, v210, v255 op_sel:[1,1,0] op_sel_hi:[1,0,1] neg_lo:[1,0,0]
  v_mfma_f32_32x32x16_bf16 v[112:127], v[164:167], v[172:175], v[112:127]
  s_waitcnt lgkmcnt(10)
  s_barrier
  buffer_load_dwordx4 v[2:5], v31, s[12:15], s32 offen offset:128 sc1
  ds_read_b64_tr_b16 v[160:161], v10 offset:0
  ds_read_b64_tr_b16 v[162:163], v10 offset:1024
  ds_read_b128 v[168:171], v14 offset:0
  v_mfma_f32_32x32x16_bf16 v[64:79], v[176:179], v[184:187], v[64:79]
  ds_read_b128 v[172:175], v14 offset:40960
  ds_read_b64_tr_b16 v[164:165], v11 offset:0
  ds_read_b64_tr_b16 v[166:167], v11 offset:1024
  ds_write_addtid_b32 v143 offset:16320
  ds_write_addtid_b32 v225 offset:16592
  ds_write_addtid_b32 v227 offset:16864
  v_mfma_f32_32x32x16_bf16 v[80:95], v[176:179], v[188:191], v[80:95]
  ds_read_b64_tr_b16 v[176:177], v10 offset:40960
  buffer_load_dwordx4 v[6:9], v31, s[12:15], s32 offen offset:2176 sc1
  ds_read_b64_tr_b16 v[178:179], v10 offset:41984
  ds_write_addtid_b32 v229 offset:17136
  ds_read_b128 a[212:215], v25 offset:8704
  v_pk_mul_f16 v229, v206, v209 op_sel:[0,0] op_sel_hi:[0,1]
  v_mfma_f32_32x32x16_bf16 v[96:111], v[180:183], v[184:187], v[96:111]
  ds_read_b128 v[184:187], v15 offset:0
  v_pk_fma_f16 v229, v206, v209, v229 op_sel:[1,1,0] op_sel_hi:[1,0,1] neg_lo:[1,0,0]
  v_pk_mul_f16 v225, v221, v210 op_sel:[0,0] op_sel_hi:[0,1]
  v_pk_mul_f16 v227, v223, v210 op_sel:[0,0] op_sel_hi:[0,1]
  v_pk_fma_f16 v224, v208, v210, v224 op_sel:[1,1,0] op_sel_hi:[1,0,1] neg_lo:[1,0,0]
  v_pk_fma_f16 v225, v221, v210, v225 op_sel:[1,1,0] op_sel_hi:[1,0,1] neg_lo:[1,0,0]
  v_mfma_f32_32x32x16_bf16 v[112:127], v[180:183], v[188:191], v[112:127]
  ds_read_b128 v[188:191], v15 offset:40960
  s_mov_b64 exec, 15
  buffer_load_dwordx4 v[144:147], v31, s[12:15], s32 offen sc1
  s_mov_b64 exec, -1
  ds_read_b128 a[224:227], v18 offset:0
  s_waitcnt lgkmcnt(13)
  v_mfma_f32_32x32x16_bf16 v[64:79], v[160:163], v[168:171], v[64:79]
  s_waitcnt lgkmcnt(12)
  ds_read_b128 a[220:223], v25 offset:8736
  ds_read_b64_tr_b16 v[180:181], v11 offset:40960
  ds_read_b64_tr_b16 v[182:183], v11 offset:41984
  ds_read_b128 a[244:247], v25 offset:8768
  v_pk_fma_f16 v226, v222, v210, v226 op_sel:[1,1,0] op_sel_hi:[1,0,1] neg_lo:[1,0,0]
  v_pk_fma_f16 v227, v223, v210, v227 op_sel:[1,1,0] op_sel_hi:[1,0,1] neg_lo:[1,0,0]
  v_mfma_f32_32x32x16_bf16 v[80:95], v[160:163], v[172:175], v[80:95]
  s_waitcnt lgkmcnt(12)
  ds_read_b128 a[252:255], v25 offset:8800
  buffer_load_dwordx4 a[40:43], v38, s[12:15], s1 offen offset:2048 sc1
  v_pk_fma_f16 v228, v209, v210, v228 op_sel:[1,1,0] op_sel_hi:[1,0,1] neg_lo:[1,0,0]
  v_cmp_ne_u32 s[44:45], v41, v37
  v_mfma_f32_32x32x16_bf16 v[96:111], v[164:167], v[168:171], v[96:111]
  ds_read_b64_tr_b16 v[160:161], v12 offset:0
  ds_read_b64_tr_b16 v[162:163], v12 offset:1024
  ds_read_b128 v[168:171], v16 offset:0
  ds_read_b128 a[228:231], v19 offset:0
  v_mfma_f32_32x32x16_bf16 v[112:127], v[164:167], v[172:175], v[112:127]
  s_waitcnt lgkmcnt(11)
  ds_read_b128 v[172:175], v16 offset:40960
  buffer_load_dwordx4 a[44:47], v38, s[12:15], s1 offen offset:3072 sc1
  s_add_u32 s1, s1, 4096
  ds_read_b64_tr_b16 v[164:165], v13 offset:0
  v_mfma_f32_32x32x16_bf16 v[64:79], v[176:179], v[184:187], v[64:79]
  ds_read_b64_tr_b16 v[166:167], v13 offset:1024
  ds_write_addtid_b32 v231 offset:17952
  ds_write_addtid_b32 v233 offset:18496
  ds_write_addtid_b32 v235 offset:19040
  v_pk_mul_f16 v231, v207, v209 op_sel:[0,0] op_sel_hi:[0,1]
  v_pk_mul_f16 v233, v220, v209 op_sel:[0,0] op_sel_hi:[0,1]
  v_mfma_f32_32x32x16_f16 v[128:143], a[208:211], a[212:215], 0
  s_waitcnt lgkmcnt(12)
  ds_read_b128 a[208:211], v25 offset:26240
  ds_read_b128 a[212:215], v25 offset:8832
  v_pk_mul_f16 v235, v208, v209 op_sel:[0,0] op_sel_hi:[0,1]
  v_pk_fma_f16 v231, v207, v209, v231 op_sel:[1,1,0] op_sel_hi:[1,0,1] neg_lo:[1,0,0]
  v_pk_fma_f16 v233, v220, v209, v233 op_sel:[1,1,0] op_sel_hi:[1,0,1] neg_lo:[1,0,0]
  v_pk_fma_f16 v235, v208, v209, v235 op_sel:[1,1,0] op_sel_hi:[1,0,1] neg_lo:[1,0,0]
  v_mfma_f32_32x32x16_bf16 v[80:95], v[176:179], v[188:191], v[80:95]
  ds_read_b64_tr_b16 v[176:177], v12 offset:40960
  ds_read_b64_tr_b16 v[178:179], v12 offset:41984
  ds_write_addtid_b32 v237 offset:19856
  ds_write_addtid_b32 v239 offset:20944
  v_pk_mul_f16 v237, v221, v209 op_sel:[0,0] op_sel_hi:[0,1]
  v_pk_mul_f16 v239, v222, v209 op_sel:[0,0] op_sel_hi:[0,1]
  v_mfma_f32_16x16x32_bf16 a[232:235], a[88:91], a[224:227], a[232:235]
  ds_write_addtid_b32 v241 offset:22032
  ds_write_addtid_b32 v230 offset:17680
  v_mfma_f32_32x32x16_f16 v[128:143], a[216:219], a[220:223], v[128:143]
  ds_read_b128 a[216:219], v25 offset:26272
  v_pk_mul_f16 v241, v223, v209 op_sel:[0,0] op_sel_hi:[0,1]
  v_pk_fma_f16 v237, v221, v209, v237 op_sel:[1,1,0] op_sel_hi:[1,0,1] neg_lo:[1,0,0]
  v_pk_fma_f16 v239, v222, v209, v239 op_sel:[1,1,0] op_sel_hi:[1,0,1] neg_lo:[1,0,0]
  v_pk_fma_f16 v241, v223, v209, v241 op_sel:[1,1,0] op_sel_hi:[1,0,1] neg_lo:[1,0,0]
  v_pk_mul_f16 v230, v229, v210 op_sel:[0,0] op_sel_hi:[0,1]
  v_mfma_f32_32x32x16_bf16 v[96:111], v[180:183], v[184:187], v[96:111]
  s_waitcnt lgkmcnt(12)
  ds_read_b128 a[220:223], v25 offset:8864
  ds_read_b128 v[184:187], v17 offset:0
  ds_write_addtid_b32 v232 offset:18224
  ds_write_addtid_b32 v234 offset:18768
  v_pk_mul_f16 v232, v231, v210 op_sel:[0,0] op_sel_hi:[0,1]
  v_pk_mul_f16 v234, v233, v210 op_sel:[0,0] op_sel_hi:[0,1]
  v_mfma_f32_32x32x16_f16 v[128:143], a[240:243], a[244:247], v[128:143]
  ds_read_b128 a[240:243], v25 offset:26304
  ds_read_b128 a[244:247], v25 offset:8896
  v_pk_fma_f16 v230, v229, v210, v230 op_sel:[1,1,0] op_sel_hi:[1,0,1] neg_lo:[1,0,0]
  v_pk_fma_f16 v232, v231, v210, v232 op_sel:[1,1,0] op_sel_hi:[1,0,1] neg_lo:[1,0,0]
  v_pk_fma_f16 v234, v233, v210, v234 op_sel:[1,1,0] op_sel_hi:[1,0,1] neg_lo:[1,0,0]
  v_mfma_f32_32x32x16_bf16 v[112:127], v[180:183], v[188:191], v[112:127]
  ds_read_b128 v[188:191], v17 offset:40960
  ds_read_b64_tr_b16 v[180:181], v13 offset:40960
  v_mfma_f32_32x32x16_f16 v[128:143], a[248:251], a[252:255], v[128:143]
  ds_read_b64_tr_b16 v[182:183], v13 offset:41984
  ds_read_b128 a[248:251], v25 offset:26336
  ds_read_b128 a[252:255], v25 offset:8928
  v_mfma_f32_32x32x16_bf16 v[64:79], v[160:163], v[168:171], v[64:79]
  s_waitcnt lgkmcnt(11)
  ds_write_addtid_b32 v236 offset:19312
  ds_write_addtid_b32 v238 offset:20128
  ds_write_addtid_b32 v238 offset:20672
  ds_write_addtid_b32 v240 offset:21216
  v_pk_mul_f16 v236, v235, v210 op_sel:[0,0] op_sel_hi:[0,1]
  v_pk_mul_f16 v238, v237, v210 op_sel:[0,0] op_sel_hi:[0,1]
  v_mfma_f32_32x32x16_f16 v[128:143], a[208:211], a[212:215], v[128:143]
  ds_write_addtid_b32 v242 offset:22304
  ds_write_addtid_b32 v215 offset:17408
  ds_write_addtid_b32 v217 offset:19584
  v_pk_mul_f16 v240, v239, v210 op_sel:[0,0] op_sel_hi:[0,1]
  v_pk_mul_f16 v242, v241, v210 op_sel:[0,0] op_sel_hi:[0,1]
  v_pk_fma_f16 v236, v235, v210, v236 op_sel:[1,1,0] op_sel_hi:[1,0,1] neg_lo:[1,0,0]
  v_mfma_f32_32x32x16_bf16 v[80:95], v[160:163], v[172:175], v[80:95]
  ds_write_addtid_b32 v218 offset:21760
  ds_write_addtid_b32 v219 offset:22848
  ds_write_addtid_b32 v243 offset:23120
  v_pk_fma_f16 v238, v237, v210, v238 op_sel:[1,1,0] op_sel_hi:[1,0,1] neg_lo:[1,0,0]
  v_pk_fma_f16 v240, v239, v210, v240 op_sel:[1,1,0] op_sel_hi:[1,0,1] neg_lo:[1,0,0]
  v_pk_fma_f16 v242, v241, v210, v242 op_sel:[1,1,0] op_sel_hi:[1,0,1] neg_lo:[1,0,0]
  v_mfma_f32_16x16x32_bf16 a[232:235], a[92:95], a[228:231], a[232:235]
  s_waitcnt lgkmcnt(13)
  ds_write_addtid_b32 v244 offset:23392
  ds_write_addtid_b32 v245 offset:23936
  v_mfma_f32_32x32x16_f16 v[128:143], a[216:219], a[220:223], v[128:143]
  ds_write_addtid_b32 v246 offset:24208
  ds_write_addtid_b32 v247 offset:24480
  v_mfma_f32_32x32x16_bf16 v[96:111], v[164:167], v[168:171], v[96:111]
  ds_write_addtid_b32 v242 offset:8432
  ds_read_b128 a[208:211], v25 offset:17408
  ds_read_b128 a[216:219], v25 offset:17440
  v_accvgpr_read_b32 v18, a232
  v_mul_f32 v18, 3216550459, v18
  v_mfma_f32_32x32x16_f16 v[128:143], a[240:243], a[244:247], v[128:143]
  ds_read_b128 a[240:243], v25 offset:17472
  v_exp_f32 v18, v18
  v_mfma_f32_32x32x16_bf16 v[112:127], v[164:167], v[172:175], v[112:127]
  s_waitcnt lgkmcnt(9)
  s_barrier
  ds_write_addtid_b32 v216 offset:0
  ds_write_addtid_b32 v206 offset:272
  ds_write_addtid_b32 v207 offset:544
  ds_write_addtid_b32 v208 offset:1088
  v_mfma_f32_32x32x16_f16 v[128:143], a[248:251], a[252:255], v[128:143]
  ds_write_addtid_b32 v209 offset:2176
  ds_write_addtid_b32 v210 offset:4352
  ds_write_addtid_b32 v253 offset:4624
  ds_write_addtid_b32 v254 offset:4896
  ds_write_addtid_b32 v220 offset:816
  ds_write_addtid_b32 v255 offset:5168
  v_mfma_f32_32x32x16_bf16 v[64:79], v[176:179], v[184:187], v[64:79]
  v_mov_b32 v216, 0
  v_add_f32 v18, 1.0, v18
  v_rcp_f32 v18, v18
  v_mfma_f32_32x32x16_bf16 v[80:95], v[176:179], v[188:191], v[80:95]
  v_mfma_f32_32x32x16_bf16 v[96:111], v[180:183], v[184:187], v[96:111]
  v_mfma_f32_32x32x16_bf16 v[112:127], v[180:183], v[188:191], v[112:127]
  s_nop 5
  v_mul_f32 v64, v64, |v64|
  v_mul_f32 v65, v65, |v65|
  v_mul_f32 v66, v66, |v66|
  v_mul_f32 v67, v67, |v67|
  v_cvt_pk_bf16_f32 v64, v64, v65
  v_mul_f32 v68, v68, |v68|
  v_mul_f32 v69, v69, |v69|
  v_mul_f32 v70, v70, |v70|
  v_mul_f32 v71, v71, |v71|
  v_cvt_pk_bf16_f32 v65, v66, v67
  v_cvt_pk_bf16_f32 v66, v68, v69
  v_cvt_pk_bf16_f32 v67, v70, v71
  v_pk_max_i16 v64, v64, 0
  v_pk_max_i16 v65, v65, 0
  v_pk_max_i16 v66, v66, 0
  v_pk_max_i16 v67, v67, 0
  v_mul_f32 v72, v72, |v72|
  v_mul_f32 v73, v73, |v73|
  v_mul_f32 v74, v74, |v74|
  v_mul_f32 v75, v75, |v75|
  v_cvt_pk_bf16_f32 v72, v72, v73
  buffer_store_dwordx4 v[64:67], v38, s[12:15], s59 offen offset:0 sc1
  v_mul_f32 v76, v76, |v76|
  v_mul_f32 v77, v77, |v77|
  v_mul_f32 v78, v78, |v78|
  v_mul_f32 v79, v79, |v79|
  v_cvt_pk_bf16_f32 v73, v74, v75
  v_cvt_pk_bf16_f32 v74, v76, v77
  v_cvt_pk_bf16_f32 v75, v78, v79
  v_pk_max_i16 v72, v72, 0
  v_pk_max_i16 v73, v73, 0
  v_pk_max_i16 v74, v74, 0
  v_pk_max_i16 v75, v75, 0
  v_mul_f32 v80, v80, |v80|
  v_mul_f32 v81, v81, |v81|
  buffer_store_dwordx4 v[72:75], v38, s[12:15], s59 offen offset:1024 sc1
  v_mul_f32 v82, v82, |v82|
  v_mul_f32 v83, v83, |v83|
  v_cvt_pk_bf16_f32 v80, v80, v81
  ds_write_addtid_b32 v224 offset:5440
  ds_write_addtid_b32 v221 offset:1360
  v_mul_f32 v84, v84, |v84|
  v_mul_f32 v85, v85, |v85|
  v_mul_f32 v86, v86, |v86|
  v_mul_f32 v87, v87, |v87|
  v_cvt_pk_bf16_f32 v81, v82, v83
  v_cvt_pk_bf16_f32 v82, v84, v85
  ds_write_addtid_b32 v225 offset:5712
  ds_write_addtid_b32 v222 offset:1632
  ds_write_addtid_b32 v226 offset:5984
  ds_write_addtid_b32 v223 offset:1904
  v_cvt_pk_bf16_f32 v83, v86, v87
  v_pk_max_i16 v80, v80, 0
  v_pk_max_i16 v81, v81, 0
  v_pk_max_i16 v82, v82, 0
  ds_write_addtid_b32 v227 offset:6256
  ds_write_addtid_b32 v228 offset:6528
  ds_write_addtid_b32 v229 offset:2448
  ds_write_addtid_b32 v230 offset:6800
  ds_write_addtid_b32 v231 offset:2720
  ds_write_addtid_b32 v232 offset:7072
  ds_write_addtid_b32 v233 offset:2992
  v_pk_max_i16 v83, v83, 0
  buffer_store_dwordx4 v[80:83], v38, s[12:15], s60 offen offset:0 sc1
  ds_write_addtid_b32 v234 offset:7344
  ds_write_addtid_b32 v235 offset:3264
  ds_write_addtid_b32 v236 offset:7616
  ds_write_addtid_b32 v237 offset:3536
  ds_write_addtid_b32 v238 offset:7888
  ds_write_addtid_b32 v239 offset:3808
  ds_write_addtid_b32 v240 offset:8160
  ds_write_addtid_b32 v241 offset:4080
  v_mul_f32 v88, v88, |v88|
  v_mul_f32 v89, v89, |v89|
  v_mul_f32 v90, v90, |v90|
  v_mul_f32 v91, v91, |v91|
  v_cvt_pk_bf16_f32 v88, v88, v89
  ds_read_b128 a[212:215], v25 offset:0
  ds_read_b128 a[220:223], v25 offset:32
  v_mul_f32 v92, v92, |v92|
  v_mul_f32 v93, v93, |v93|
  v_mul_f32 v94, v94, |v94|
  v_mul_f32 v95, v95, |v95|
  v_cvt_pk_bf16_f32 v89, v90, v91
  v_cvt_pk_bf16_f32 v90, v92, v93
  v_cvt_pk_bf16_f32 v91, v94, v95
  v_pk_max_i16 v88, v88, 0
  v_pk_max_i16 v89, v89, 0
  v_pk_max_i16 v90, v90, 0
  v_pk_max_i16 v91, v91, 0
  v_mul_f32 v96, v96, |v96|
  v_mul_f32 v97, v97, |v97|
  v_mul_f32 v98, v98, |v98|
  v_mul_f32 v99, v99, |v99|
  buffer_store_dwordx4 v[88:91], v38, s[12:15], s60 offen offset:1024 sc1
  v_cvt_pk_bf16_f32 v96, v96, v97
  v_mul_f32 v100, v100, |v100|
  ds_read_b128 a[244:247], v25 offset:64
  v_mul_f32 v101, v101, |v101|
  v_mul_f32 v102, v102, |v102|
  v_mul_f32 v103, v103, |v103|
  v_cvt_pk_bf16_f32 v97, v98, v99
  v_cvt_pk_bf16_f32 v98, v100, v101
  v_cvt_pk_bf16_f32 v99, v102, v103
  s_waitcnt lgkmcnt(2)
  v_mfma_f32_32x32x16_f16 v[128:143], a[208:211], a[212:215], v[128:143]
  v_pk_max_i16 v96, v96, 0
  v_pk_max_i16 v97, v97, 0
  v_pk_max_i16 v98, v98, 0
  v_pk_max_i16 v99, v99, 0
  v_mul_f32 v104, v104, |v104|
  v_mul_f32 v105, v105, |v105|
  s_waitcnt lgkmcnt(1)
  buffer_store_dwordx4 v[96:99], v38, s[12:15], s59 offen offset:2048 sc1
  v_mul_f32 v106, v106, |v106|
  v_mul_f32 v107, v107, |v107|
  v_mfma_f32_32x32x16_f16 v[128:143], a[216:219], a[220:223], v[128:143]
  ds_read_b128 a[248:251], v25 offset:17504
  v_cvt_pk_bf16_f32 v104, v104, v105
  v_mul_f32 v108, v108, |v108|
  v_mul_f32 v109, v109, |v109|
  v_mul_f32 v110, v110, |v110|
  v_mul_f32 v111, v111, |v111|
  s_waitcnt lgkmcnt(1)
  ds_read_b128 a[252:255], v25 offset:96
  v_cvt_pk_bf16_f32 v105, v106, v107
  v_cvt_pk_bf16_f32 v106, v108, v109
  v_cvt_pk_bf16_f32 v107, v110, v111
  v_pk_max_i16 v104, v104, 0
  v_pk_max_i16 v105, v105, 0
  v_pk_max_i16 v106, v106, 0
  v_mfma_f32_32x32x16_f16 v[128:143], a[240:243], a[244:247], v[128:143]
  v_pk_max_i16 v107, v107, 0
  v_mul_f32 v112, v112, |v112|
  v_mul_f32 v113, v113, |v113|
  v_mul_f32 v114, v114, |v114|
  v_mul_f32 v115, v115, |v115|
  v_cvt_pk_bf16_f32 v112, v112, v113
  buffer_store_dwordx4 v[104:107], v38, s[12:15], s59 offen offset:3072 sc1
  v_mul_f32 v116, v116, |v116|
  v_mul_f32 v117, v117, |v117|
  s_waitcnt lgkmcnt(0)
  ds_read_b128 a[208:211], v25 offset:17536
  ds_read_b128 a[212:215], v25 offset:128
  v_mul_f32 v118, v118, |v118|
  v_mul_f32 v119, v119, |v119|
  v_cvt_pk_bf16_f32 v113, v114, v115
  v_cvt_pk_bf16_f32 v114, v116, v117
  v_cvt_pk_bf16_f32 v115, v118, v119
  v_mfma_f32_32x32x16_f16 v[128:143], a[248:251], a[252:255], v[128:143]
  v_pk_max_i16 v112, v112, 0
  v_pk_max_i16 v113, v113, 0
  v_pk_max_i16 v114, v114, 0
  v_pk_max_i16 v115, v115, 0
  v_mul_f32 v120, v120, |v120|
  v_mul_f32 v121, v121, |v121|
  buffer_store_dwordx4 v[112:115], v38, s[12:15], s60 offen offset:2048 sc1
  v_mul_f32 v122, v122, |v122|
  v_mul_f32 v123, v123, |v123|
  ds_read_b128 a[216:219], v25 offset:17568
  ds_read_b128 a[220:223], v25 offset:160
  v_cvt_pk_bf16_f32 v120, v120, v121
  v_mul_f32 v124, v124, |v124|
  v_mul_f32 v125, v125, |v125|
  v_mul_f32 v126, v126, |v126|
  v_mul_f32 v127, v127, |v127|
  s_waitcnt lgkmcnt(2)
  v_mfma_f32_32x32x16_f16 v[128:143], a[208:211], a[212:215], v[128:143]
  s_waitcnt vmcnt(9)
  ds_read_b128 a[240:243], v25 offset:17600
  ds_read_b128 a[244:247], v25 offset:192
  ds_read_b128 a[248:251], v25 offset:17632
  ds_read_b128 a[252:255], v25 offset:224
  v_cvt_pk_bf16_f32 v121, v122, v123
  v_cvt_pk_bf16_f32 v122, v124, v125
  v_cvt_pk_bf16_f32 v123, v126, v127
  v_pk_max_i16 v120, v120, 0
  v_pk_max_i16 v121, v121, 0
  v_pk_max_i16 v122, v122, 0
  v_pk_max_i16 v123, v123, 0
  v_and_b32 v144, s33, v144
  v_and_b32 v145, s33, v145
  v_and_b32 v146, s33, v146
  v_and_b32 v147, s33, v147
  buffer_store_dwordx4 v[120:123], v38, s[12:15], s60 offen offset:3072 sc1
  v_lshlrev_b32 v156, 16, v144
  v_alignbit_b32 v157, v145, v144, 16
  s_waitcnt lgkmcnt(4)
  v_mfma_f32_32x32x16_f16 v[128:143], a[216:219], a[220:223], v[128:143]
  v_alignbit_b32 v158, v146, v145, 16
  v_alignbit_b32 v159, v147, v146, 16
  v_lshlrev_b32 v148, 16, v2
  v_alignbit_b32 v149, v3, v2, 16
  v_alignbit_b32 v150, v4, v3, 16
  v_alignbit_b32 v151, v5, v4, 16
  s_waitcnt lgkmcnt(2)
  s_mov_b64 exec, 15
  ds_write_b128 v32, v[144:147] offset:0
  s_mov_b64 exec, -1
  v_mfma_f32_32x32x16_f16 v[128:143], a[240:243], a[244:247], v[128:143]
  s_mov_b64 exec, 15
  ds_write_b128 v32, v[156:159] offset:1088
  s_mov_b64 exec, -1
  s_waitcnt lgkmcnt(2)
  ds_write_b128 v32, v[148:151] offset:1120
  v_lshlrev_b32 v152, 16, v6
  v_alignbit_b32 v153, v7, v6, 16
  v_alignbit_b32 v154, v8, v7, 16
  v_alignbit_b32 v155, v9, v8, 16
  v_mfma_f32_32x32x16_f16 v[128:143], a[248:251], a[252:255], v[128:143]
  ds_write_b128 v32, v[152:155] offset:1632
  s_nop 10
  v_mul_f32 v128, v63, v128
  v_mul_f32 v129, v63, v129
  v_mul_f32 v130, v63, v130
  v_mul_f32 v131, v63, v131
  v_mul_f32 v132, v63, v132
  v_mul_f32 v133, v63, v133
  v_mul_f32 v134, v63, v134
  v_mul_f32 v136, v63, v136
  v_mul_f32 v137, v63, v137
  v_mul_f32 v138, v63, v138
  v_mul_f32 v140, v63, v140
  ds_write_b128 v32, v[2:5] offset:32
  v_mul_f32 v141, v63, v141
  v_mul_f32 v142, v63, v142
  v_mul_f32 v143, v63, v143
  ds_write_b128 v32, v[6:9] offset:544
  ds_write_b16_d16_hi v32, v5 offset:1136
  buffer_load_dwordx4 a[48:51], v38, s[12:15], s1 offen offset:0 sc1
  ds_write_b128 v39, v[128:131] offset:29696
  ds_write_b128 v39, v[132:135] offset:30720
  ds_write_b128 v39, v[136:139] offset:31744
  ds_write_b128 v39, v[140:143] offset:32768
  s_mov_b64 exec, 15
  ds_write_b16_d16_hi v32, v147 offset:1104
  s_mov_b64 exec, -1
  ds_write_b16_d16_hi v32, v9 offset:1648
  buffer_load_dwordx4 a[52:55], v38, s[12:15], s1 offen offset:1024 sc1
  buffer_load_dwordx4 a[56:59], v38, s[12:15], s1 offen offset:2048 sc1
  buffer_load_dwordx4 a[60:63], v38, s[12:15], s1 offen offset:3072 sc1
  v_add_f32 v128, v128, v30
  ds_write_addtid_b32 v216 offset:28672
  ds_write_addtid_b32 v216 offset:28928
  ds_write_addtid_b32 v216 offset:29184
  ds_write_addtid_b32 v216 offset:29440
  buffer_load_dwordx4 a[64:67], v38, s[12:15], s25 offen offset:0 sc1
  buffer_load_dwordx4 a[68:71], v38, s[12:15], s25 offen offset:1024 sc1
  ds_write_addtid_b32 v18 offset:40448
  buffer_load_dwordx4 a[72:75], v38, s[12:15], s25 offen offset:2048 sc1
  buffer_load_dwordx4 a[76:79], v38, s[12:15], s25 offen offset:3072 sc1
  s_add_u32 s25, s25, 4096
  s_waitcnt lgkmcnt(5)
  s_barrier
  ds_read_b128 v[236:239], v62 offset:32768
  ds_read_b128 v[232:235], v62 offset:31744
  ds_read_b128 v[224:227], v62 offset:29696
  ds_read_b128 v[228:231], v62 offset:30720
  ds_read2_b32 v[192:193], v20 offset0:48 offset1:49
  ds_read2_b32 v[194:195], v20 offset0:50 offset1:51
  ds_read2_b32 v[196:197], v20 offset0:176 offset1:177
  ds_read2_b32 v[198:199], v20 offset0:178 offset1:179
  ds_read2_b32 v[200:201], v21 offset0:48 offset1:49
  ds_read2_b32 v[202:203], v21 offset0:50 offset1:51
  ds_read2_b32 v[204:205], v21 offset0:176 offset1:177
  ds_read2_b32 v[206:207], v21 offset0:178 offset1:179
  buffer_load_dwordx4 a[80:83], v38, s[12:15], s25 offen offset:0 sc1
  ds_read2_b32 v[208:209], v22 offset0:48 offset1:49
  ds_read2_b32 v[210:211], v22 offset0:50 offset1:51
  ds_read2_b32 v[212:213], v22 offset0:176 offset1:177
  buffer_load_dwordx4 a[84:87], v38, s[12:15], s25 offen offset:1024 sc1
  s_waitcnt lgkmcnt(14)
  v_add_f32 v140, v140, v236
  v_add_f32 v141, v141, v237
  v_add_f32 v142, v142, v238
  v_add_f32 v143, v143, v239
  v_cndmask_b32 v249, v140, v141, s[100:101]
  v_cndmask_b32 v253, v142, v143, s[100:101]
  v_cvt_pk_bf16_f32 v248, v141, v141
  v_cvt_pk_bf16_f32 v249, v141, v249
  v_cvt_pk_bf16_f32 v250, v140, v140
  s_waitcnt lgkmcnt(12)
  v_add_f32 v136, v136, v232
  v_add_f32 v137, v137, v233
  v_add_f32 v138, v138, v234
  v_cvt_pk_bf16_f32 v244, v138, v138
  v_cvt_pk_bf16_f32 v245, v137, v137
  v_cvt_pk_bf16_f32 v246, v137, v136
  v_cvt_pk_bf16_f32 v247, v136, v136
  v_cvt_pk_bf16_f32 v251, v140, v140
  v_cvt_pk_bf16_f32 v252, v143, v143
  s_waitcnt lgkmcnt(9)
  v_cvt_pk_bf16_f32 v253, v143, v253
  v_cvt_pk_bf16_f32 v254, v142, v142
  v_cvt_pk_bf16_f32 v255, v142, v142
  v_add_f32 v128, v128, v224
  v_add_f32 v129, v129, v225
  v_add_f32 v130, v130, v226
  v_add_f32 v131, v131, v227
  v_add_f32 v132, v132, v228
  v_add_f32 v133, v133, v229
  ds_write_b128 v28, v[244:247] offset:1536
  v_add_f32 v134, v134, v230
  v_cvt_pk_bf16_f32 v240, v131, v130
  v_cvt_pk_bf16_f32 v241, v129, v128
  ds_write_b128 v29, v[248:251] offset:512
  ds_write_b64 v27, v[240:241] offset:2568
  ds_write_b128 v29, v[252:255] offset:0
  buffer_load_dwordx4 a[88:91], v38, s[12:15], s25 offen offset:2048 sc1
  buffer_load_dwordx4 a[92:95], v38, s[12:15], s25 offen offset:3072 sc1
  buffer_load_dwordx4 a[96:99], v38, s[12:15], s27 offen offset:0 sc1
  v_cvt_pk_bf16_f32 v242, v134, v133
  v_cvt_pk_bf16_f32 v243, v132, v132
  ds_write_b64 v27, v[242:243] offset:2056
  ds_read_b128 v[224:227], v24 offset:3776
  ds_read_b128 v[228:231], v24 offset:3264
  ds_read_b128 v[232:235], v24 offset:2752
  ds_read_b128 v[236:239], v24 offset:2240
  ds_read_b128 v[240:243], v24 offset:1728
  ds_read2_b32 v[214:215], v22 offset0:178 offset1:179
  buffer_load_dwordx4 a[100:103], v38, s[12:15], s27 offen offset:1024 sc1
  ds_read_b128 v[244:247], v24 offset:1216
  ds_read2_b32 v[216:217], v23 offset0:48 offset1:49
  ds_read2_b32 v[218:219], v23 offset0:50 offset1:51
  ds_read_b128 v[248:251], v24 offset:704
  ds_read2_b32 v[220:221], v23 offset0:176 offset1:177
  ds_read2_b32 v[222:223], v23 offset0:178 offset1:179
  buffer_load_dwordx4 a[104:107], v38, s[12:15], s27 offen offset:2048 sc1
  ds_read_b128 v[252:255], v24 offset:192
  ds_read2_b32 v[130:131], v20 offset0:34 offset1:35
  buffer_load_dwordx4 a[108:111], v38, s[12:15], s27 offen offset:3072 sc1
  s_add_u32 s27, s27, 4096
  ds_read2_b32 v[128:129], v20 offset0:32 offset1:33
  s_waitcnt lgkmcnt(14)
  v_mfma_f32_16x16x32_bf16 a[224:227], v[192:195], v[224:227], 0
  v_mfma_f32_16x16x32_bf16 a[228:231], v[196:199], v[224:227], 0
  s_waitcnt lgkmcnt(13)
  v_mfma_f32_16x16x32_bf16 a[228:231], v[192:195], v[228:231], a[228:231]
  buffer_load_dwordx4 a[112:115], v38, s[12:15], s27 offen offset:0 sc1
  v_mfma_f32_16x16x32_bf16 a[232:235], v[196:199], v[228:231], 0
  v_mfma_f32_16x16x32_bf16 a[232:235], v[200:203], v[224:227], a[232:235]
  s_waitcnt lgkmcnt(10)
  v_mfma_f32_16x16x32_bf16 a[232:235], v[192:195], v[232:235], a[232:235]
  ds_read_b128 v[160:163], v24 offset:3712
  ds_read2_b32 v[132:133], v20 offset0:160 offset1:161
  v_mfma_f32_16x16x32_bf16 a[236:239], v[200:203], v[228:231], 0
  buffer_load_dwordx4 a[116:119], v38, s[12:15], s27 offen offset:1024 sc1
  ds_read2_b32 v[134:135], v20 offset0:162 offset1:163
  v_mfma_f32_16x16x32_bf16 a[236:239], v[196:199], v[232:235], a[236:239]
  v_mfma_f32_16x16x32_bf16 a[240:243], v[200:203], v[232:235], 0
  ds_read_b128 v[164:167], v24 offset:3200
  ds_read2_b32 v[136:137], v21 offset0:32 offset1:33
  v_mfma_f32_16x16x32_bf16 a[236:239], v[204:207], v[224:227], a[236:239]
  v_mfma_f32_16x16x32_bf16 a[236:239], v[192:195], v[236:239], a[236:239]
  s_waitcnt vmcnt(18)
  s_mov_b64 exec, 1
  buffer_store_dword v40, off, s[12:15], s65 sc1
  s_mov_b64 exec, -1
  v_mfma_f32_16x16x32_bf16 a[240:243], v[204:207], v[228:231], a[240:243]
  ds_read2_b32 v[138:139], v21 offset0:34 offset1:35
  ds_read_b128 v[168:171], v24 offset:2688
  v_mfma_f32_16x16x32_bf16 a[240:243], v[196:199], v[236:239], a[240:243]
  ds_read2_b32 v[140:141], v21 offset0:160 offset1:161
  ds_read2_b32 v[142:143], v21 offset0:162 offset1:163
  v_mfma_f32_16x16x32_bf16 a[244:247], v[204:207], v[232:235], 0
  ds_read_b128 v[172:175], v24 offset:2176
  buffer_load_dwordx4 a[120:123], v38, s[12:15], s27 offen offset:2048 sc1
  v_mfma_f32_16x16x32_bf16 a[244:247], v[200:203], v[236:239], a[244:247]
  ds_read2_b32 v[144:145], v22 offset0:32 offset1:33
  buffer_load_dwordx4 a[124:127], v38, s[12:15], s27 offen offset:3072 sc1
  v_mfma_f32_16x16x32_bf16 a[248:251], v[204:207], v[236:239], 0
  ds_read2_b32 v[146:147], v22 offset0:34 offset1:35
  v_mfma_f32_16x16x32_bf16 a[240:243], v[208:211], v[224:227], a[240:243]
  ds_read_b128 v[176:179], v24 offset:1664
  v_mfma_f32_16x16x32_bf16 a[240:243], v[192:195], v[240:243], a[240:243]
  ds_read2_b32 v[148:149], v22 offset0:160 offset1:161
  v_mfma_f32_16x16x32_bf16 a[244:247], v[208:211], v[228:231], a[244:247]
  ds_read2_b32 v[150:151], v22 offset0:162 offset1:163
  buffer_load_dwordx4 a[128:131], v38, s[12:15], s29 offen offset:0 sc1
  v_mfma_f32_16x16x32_bf16 a[244:247], v[196:199], v[240:243], a[244:247]
  ds_read_b128 v[180:183], v24 offset:1152
  v_mfma_f32_16x16x32_bf16 a[248:251], v[208:211], v[232:235], a[248:251]
  ds_read2_b32 v[152:153], v23 offset0:32 offset1:33
  v_mfma_f32_16x16x32_bf16 a[248:251], v[200:203], v[240:243], a[248:251]
  ds_read2_b32 v[154:155], v23 offset0:34 offset1:35
  v_mfma_f32_16x16x32_bf16 a[252:255], v[208:211], v[236:239], 0
  ds_read_b128 v[184:187], v24 offset:640
  buffer_load_dwordx4 a[132:135], v38, s[12:15], s29 offen offset:1024 sc1
  v_mfma_f32_16x16x32_bf16 a[252:255], v[204:207], v[240:243], a[252:255]
  s_waitcnt lgkmcnt(9)
  ds_read2_b32 v[156:157], v23 offset0:160 offset1:161
  v_mfma_f32_16x16x32_bf16 a[244:247], v[212:215], v[224:227], a[244:247]
  ds_read2_b32 v[158:159], v23 offset0:162 offset1:163
  v_mfma_f32_16x16x32_bf16 a[244:247], v[192:195], v[244:247], a[244:247]
  ds_read_b128 v[188:191], v24 offset:128
  v_mfma_f32_16x16x32_bf16 a[248:251], v[212:215], v[228:231], a[248:251]
  ds_read2_b32 v[204:205], v21 offset0:144 offset1:145
  buffer_load_dwordx4 a[136:139], v38, s[12:15], s29 offen offset:2048 sc1
  v_mfma_f32_16x16x32_bf16 a[248:251], v[196:199], v[244:247], a[248:251]
  ds_read2_b32 v[206:207], v21 offset0:146 offset1:147
  v_mfma_f32_16x16x32_bf16 a[252:255], v[212:215], v[232:235], a[252:255]
  ds_read_b128 v[232:235], v24 offset:2624
  v_mfma_f32_16x16x32_bf16 a[252:255], v[200:203], v[244:247], a[252:255]
  ds_read2_b32 v[200:201], v21 offset0:16 offset1:17
  v_mfma_f32_16x16x32_bf16 a[248:251], v[216:219], v[224:227], a[248:251]
  ds_read2_b32 v[202:203], v21 offset0:18 offset1:19
  buffer_load_dwordx4 a[140:143], v38, s[12:15], s29 offen offset:3072 sc1
  v_mfma_f32_16x16x32_bf16 a[248:251], v[192:195], v[248:251], a[248:251]
  s_add_u32 s29, s29, 4096
  ds_read_b128 v[236:239], v24 offset:2112
  v_mfma_f32_16x16x32_bf16 a[252:255], v[216:219], v[228:231], a[252:255]
  ds_read_b128 v[228:231], v24 offset:3136
  v_mfma_f32_16x16x32_bf16 a[252:255], v[196:199], v[248:251], a[252:255]
  ds_read2_b32 v[196:197], v20 offset0:144 offset1:145
  v_mfma_f32_16x16x32_bf16 a[252:255], v[220:223], v[224:227], a[252:255]
  ds_read_b128 v[224:227], v24 offset:3648
  buffer_load_dwordx4 a[144:147], v38, s[12:15], s29 offen offset:0 sc1
  v_mfma_f32_16x16x32_bf16 a[252:255], v[192:195], v[252:255], a[252:255]
  ds_read2_b32 v[192:193], v20 offset0:16 offset1:17
  v_mfma_f32_16x16x32_bf16 a[224:227], v[128:131], v[160:163], a[224:227]
  ds_read2_b32 v[194:195], v20 offset0:18 offset1:19
  v_mfma_f32_16x16x32_bf16 a[228:231], v[132:135], v[160:163], a[228:231]
  ds_read2_b32 v[198:199], v20 offset0:146 offset1:147
  v_mfma_f32_16x16x32_bf16 a[228:231], v[128:131], v[164:167], a[228:231]
  ds_read2_b32 v[208:209], v22 offset0:16 offset1:17
  buffer_load_dwordx4 a[148:151], v38, s[12:15], s29 offen offset:1024 sc1
  v_mfma_f32_16x16x32_bf16 a[232:235], v[132:135], v[164:167], a[232:235]
  ds_read2_b32 v[210:211], v22 offset0:18 offset1:19
  v_mfma_f32_16x16x32_bf16 a[232:235], v[136:139], v[160:163], a[232:235]
  s_barrier
  v_mfma_f32_16x16x32_bf16 a[232:235], v[128:131], v[168:171], a[232:235]
  ds_read_b128 v[240:243], v24 offset:1600
  ds_read2_b32 v[212:213], v22 offset0:144 offset1:145
  v_mfma_f32_16x16x32_bf16 a[236:239], v[136:139], v[164:167], a[236:239]
  ds_read2_b32 v[214:215], v22 offset0:146 offset1:147
  buffer_load_dwordx4 a[152:155], v38, s[12:15], s29 offen offset:2048 sc1
  v_mfma_f32_16x16x32_bf16 a[236:239], v[132:135], v[168:171], a[236:239]
  ds_read_b128 v[244:247], v24 offset:1088
  v_mfma_f32_16x16x32_bf16 a[240:243], v[136:139], v[168:171], a[240:243]
  ds_read2_b32 v[216:217], v23 offset0:16 offset1:17
  v_mfma_f32_16x16x32_bf16 a[236:239], v[140:143], v[160:163], a[236:239]
  ds_read2_b32 v[218:219], v23 offset0:18 offset1:19
  v_mfma_f32_16x16x32_bf16 a[236:239], v[128:131], v[172:175], a[236:239]
  ds_read_b128 v[248:251], v24 offset:576
  buffer_load_dwordx4 a[156:159], v38, s[12:15], s29 offen offset:3072 sc1
  v_mfma_f32_16x16x32_bf16 a[240:243], v[140:143], v[164:167], a[240:243]
  ds_read2_b32 v[220:221], v23 offset0:144 offset1:145
  v_mfma_f32_16x16x32_bf16 a[240:243], v[132:135], v[172:175], a[240:243]
  ds_read2_b32 v[222:223], v23 offset0:146 offset1:147
  v_mfma_f32_16x16x32_bf16 a[244:247], v[140:143], v[168:171], a[244:247]
  ds_read_b128 v[252:255], v24 offset:64
  v_mfma_f32_16x16x32_bf16 a[244:247], v[136:139], v[172:175], a[244:247]
  buffer_load_dwordx4 a[160:163], v38, s[12:15], s31 offen offset:0 sc1
  v_mfma_f32_16x16x32_bf16 a[248:251], v[140:143], v[172:175], a[248:251]
  s_waitcnt lgkmcnt(8)
  v_mfma_f32_16x16x32_bf16 a[240:243], v[144:147], v[160:163], a[240:243]
  v_mfma_f32_16x16x32_bf16 a[240:243], v[128:131], v[176:179], a[240:243]
  v_mfma_f32_16x16x32_bf16 a[244:247], v[144:147], v[164:167], a[244:247]
  buffer_load_dwordx4 a[164:167], v38, s[12:15], s31 offen offset:1024 sc1
  v_mfma_f32_16x16x32_bf16 a[244:247], v[132:135], v[176:179], a[244:247]
  v_mfma_f32_16x16x32_bf16 a[248:251], v[144:147], v[168:171], a[248:251]
  v_mfma_f32_16x16x32_bf16 a[248:251], v[136:139], v[176:179], a[248:251]
  v_mfma_f32_16x16x32_bf16 a[252:255], v[144:147], v[172:175], a[252:255]
  ds_read_b128 v[172:175], v24 offset:2048
  ds_read2_b32 v[144:145], v22 offset0:0 offset1:1
  v_mfma_f32_16x16x32_bf16 a[252:255], v[140:143], v[176:179], a[252:255]
  ds_read2_b32 v[140:141], v21 offset0:128 offset1:129
  ds_read2_b32 v[142:143], v21 offset0:130 offset1:131
  v_mfma_f32_16x16x32_bf16 a[244:247], v[148:151], v[160:163], a[244:247]
  ds_read2_b32 v[146:147], v22 offset0:2 offset1:3
  ds_read_b128 v[176:179], v24 offset:1536
  v_mfma_f32_16x16x32_bf16 a[244:247], v[128:131], v[180:183], a[244:247]
  buffer_load_dwordx4 a[168:171], v38, s[12:15], s31 offen offset:2048 sc1
  v_mfma_f32_16x16x32_bf16 a[248:251], v[148:151], v[164:167], a[248:251]
  buffer_load_dwordx4 a[172:175], v38, s[12:15], s31 offen offset:3072 sc1
  s_add_u32 s31, s31, 4096
  v_mfma_f32_16x16x32_bf16 a[248:251], v[132:135], v[180:183], a[248:251]
  v_mfma_f32_16x16x32_bf16 a[252:255], v[148:151], v[168:171], a[252:255]
  ds_read_b128 v[168:171], v24 offset:2560
  ds_read2_b32 v[148:149], v22 offset0:128 offset1:129
  v_mfma_f32_16x16x32_bf16 a[252:255], v[136:139], v[180:183], a[252:255]
  ds_read2_b32 v[136:137], v21 offset0:0 offset1:1
  ds_read2_b32 v[138:139], v21 offset0:2 offset1:3
  v_mfma_f32_16x16x32_bf16 a[248:251], v[152:155], v[160:163], a[248:251]
  ds_read2_b32 v[150:151], v22 offset0:130 offset1:131
  ds_read_b128 v[180:183], v24 offset:1024
  v_mfma_f32_16x16x32_bf16 a[248:251], v[128:131], v[184:187], a[248:251]
  buffer_load_dwordx4 a[176:179], v38, s[12:15], s31 offen offset:0 sc1
  v_mfma_f32_16x16x32_bf16 a[252:255], v[152:155], v[164:167], a[252:255]
  ds_read_b128 v[164:167], v24 offset:3072
  ds_read2_b32 v[152:153], v23 offset0:0 offset1:1
  v_mfma_f32_16x16x32_bf16 a[252:255], v[132:135], v[184:187], a[252:255]
  ds_read2_b32 v[132:133], v20 offset0:128 offset1:129
  v_mfma_f32_16x16x32_bf16 a[252:255], v[156:159], v[160:163], a[252:255]
  buffer_load_dword v36, v35, s[12:15], s34 offen sc1
  ds_read_b128 v[160:163], v24 offset:3584
  v_mfma_f32_16x16x32_bf16 a[252:255], v[128:131], v[188:191], a[252:255]
  ds_read2_b32 v[128:129], v20 offset0:0 offset1:1
  buffer_load_dwordx4 a[180:183], v38, s[12:15], s31 offen offset:1024 sc1
  v_mfma_f32_16x16x32_bf16 a[224:227], v[192:195], v[224:227], a[224:227]
  ds_read2_b32 v[130:131], v20 offset0:2 offset1:3
  v_mfma_f32_16x16x32_bf16 a[228:231], v[196:199], v[224:227], a[228:231]
  ds_read2_b32 v[134:135], v20 offset0:130 offset1:131
  v_mfma_f32_16x16x32_bf16 a[228:231], v[192:195], v[228:231], a[228:231]
  ds_read2_b32 v[154:155], v23 offset0:2 offset1:3
  v_mfma_f32_16x16x32_bf16 a[232:235], v[196:199], v[228:231], a[232:235]
  ds_read_b128 v[184:187], v24 offset:512
  buffer_load_dwordx4 a[184:187], v38, s[12:15], s31 offen offset:2048 sc1
  v_mfma_f32_16x16x32_bf16 a[232:235], v[200:203], v[224:227], a[232:235]
  ds_read2_b32 v[156:157], v23 offset0:128 offset1:129
  v_mfma_f32_16x16x32_bf16 a[232:235], v[192:195], v[232:235], a[232:235]
  ds_read2_b32 v[158:159], v23 offset0:130 offset1:131
  v_mfma_f32_16x16x32_bf16 a[236:239], v[200:203], v[228:231], a[236:239]
  ds_read_b128 v[188:191], v24 offset:0
  v_mfma_f32_16x16x32_bf16 a[236:239], v[196:199], v[232:235], a[236:239]
  buffer_load_dwordx4 a[188:191], v38, s[12:15], s31 offen offset:3072 sc1
  v_mfma_f32_16x16x32_bf16 a[240:243], v[200:203], v[232:235], a[240:243]
  v_mfma_f32_16x16x32_bf16 a[236:239], v[204:207], v[224:227], a[236:239]
  v_mfma_f32_16x16x32_bf16 a[236:239], v[192:195], v[236:239], a[236:239]
  v_mfma_f32_16x16x32_bf16 a[240:243], v[204:207], v[228:231], a[240:243]
  buffer_load_dwordx4 a[192:195], v38, s[12:15], s37 offen offset:0 sc1
  v_mfma_f32_16x16x32_bf16 a[240:243], v[196:199], v[236:239], a[240:243]
  v_mfma_f32_16x16x32_bf16 a[244:247], v[204:207], v[232:235], a[244:247]
  v_mfma_f32_16x16x32_bf16 a[244:247], v[200:203], v[236:239], a[244:247]
  v_mfma_f32_16x16x32_bf16 a[248:251], v[204:207], v[236:239], a[248:251]
  buffer_load_dwordx4 a[196:199], v38, s[12:15], s37 offen offset:1024 sc1
  v_mfma_f32_16x16x32_bf16 a[240:243], v[208:211], v[224:227], a[240:243]
  v_mfma_f32_16x16x32_bf16 a[240:243], v[192:195], v[240:243], a[240:243]
  v_mfma_f32_16x16x32_bf16 a[244:247], v[208:211], v[228:231], a[244:247]
  v_mfma_f32_16x16x32_bf16 a[244:247], v[196:199], v[240:243], a[244:247]
  buffer_load_dwordx4 a[200:203], v38, s[12:15], s37 offen offset:2048 sc1
  v_mfma_f32_16x16x32_bf16 a[248:251], v[208:211], v[232:235], a[248:251]
  v_mfma_f32_16x16x32_bf16 a[248:251], v[200:203], v[240:243], a[248:251]
  v_mfma_f32_16x16x32_bf16 a[252:255], v[208:211], v[236:239], a[252:255]
  v_mfma_f32_16x16x32_bf16 a[252:255], v[204:207], v[240:243], a[252:255]
  s_waitcnt lgkmcnt(0)
  buffer_load_dwordx4 a[204:207], v38, s[12:15], s37 offen offset:3072 sc1
  s_add_u32 s37, s37, 4096
  v_mfma_f32_16x16x32_bf16 a[244:247], v[212:215], v[224:227], a[244:247]
  v_mfma_f32_16x16x32_bf16 a[244:247], v[192:195], v[244:247], a[244:247]
  v_mfma_f32_16x16x32_bf16 a[248:251], v[212:215], v[228:231], a[248:251]
  v_mfma_f32_16x16x32_bf16 a[248:251], v[196:199], v[244:247], a[248:251]
  buffer_load_dwordx4 a[208:211], v38, s[12:15], s37 offen offset:0 sc1
  v_mfma_f32_16x16x32_bf16 a[252:255], v[212:215], v[232:235], a[252:255]
  v_mfma_f32_16x16x32_bf16 a[252:255], v[200:203], v[244:247], a[252:255]
  v_mfma_f32_16x16x32_bf16 a[248:251], v[216:219], v[224:227], a[248:251]
  v_mfma_f32_16x16x32_bf16 a[248:251], v[192:195], v[248:251], a[248:251]
  buffer_load_dwordx4 a[212:215], v38, s[12:15], s37 offen offset:1024 sc1
  v_mfma_f32_16x16x32_bf16 a[252:255], v[216:219], v[228:231], a[252:255]
  v_mfma_f32_16x16x32_bf16 a[252:255], v[196:199], v[248:251], a[252:255]
  v_mfma_f32_16x16x32_bf16 a[252:255], v[220:223], v[224:227], a[252:255]
  v_mfma_f32_16x16x32_bf16 a[252:255], v[192:195], v[252:255], a[252:255]
  buffer_load_dwordx4 a[216:219], v38, s[12:15], s37 offen offset:2048 sc1
  v_mfma_f32_16x16x32_bf16 a[224:227], v[128:131], v[160:163], a[224:227]
  v_mfma_f32_16x16x32_bf16 a[228:231], v[132:135], v[160:163], a[228:231]
  v_mfma_f32_16x16x32_bf16 a[228:231], v[128:131], v[164:167], a[228:231]
  s_waitcnt vmcnt(10)
  v_cmp_ne_u32 vcc, s61, v36
  s_cbranch_vccnz Lspin_h
Lok_h:
  v_mfma_f32_16x16x32_bf16 a[232:235], v[136:139], v[160:163], a[232:235]
  buffer_load_dwordx4 v[68:71], v38, s[12:15], s50 offen offset:0 sc1
  v_mfma_f32_16x16x32_bf16 a[232:235], v[132:135], v[164:167], a[232:235]
  ds_write_b128 v48, a[224:227] offset:0
  v_mfma_f32_16x16x32_bf16 a[232:235], v[128:131], v[168:171], a[232:235]
  ds_write_b128 v48, a[228:231] offset:1024
  v_mfma_f32_16x16x32_bf16 a[236:239], v[140:143], v[160:163], a[236:239]
  buffer_load_dwordx4 v[76:79], v38, s[12:15], s50 offen offset:1024 sc1
  v_mfma_f32_16x16x32_bf16 a[236:239], v[136:139], v[164:167], a[236:239]
  v_mfma_f32_16x16x32_bf16 a[236:239], v[132:135], v[168:171], a[236:239]
  v_mfma_f32_16x16x32_bf16 a[236:239], v[128:131], v[172:175], a[236:239]
  v_mfma_f32_16x16x32_bf16 a[240:243], v[144:147], v[160:163], a[240:243]
  buffer_load_dwordx4 v[84:87], v38, s[12:15], s50 offen offset:2048 sc1
  ds_write_b128 v48, a[232:235] offset:2048
  v_mfma_f32_16x16x32_bf16 a[240:243], v[140:143], v[164:167], a[240:243]
  v_mfma_f32_16x16x32_bf16 a[240:243], v[136:139], v[168:171], a[240:243]
  v_mfma_f32_16x16x32_bf16 a[240:243], v[132:135], v[172:175], a[240:243]
  buffer_load_dwordx4 v[92:95], v38, s[12:15], s50 offen offset:3072 sc1
  v_mfma_f32_16x16x32_bf16 a[240:243], v[128:131], v[176:179], a[240:243]
  ds_write_b128 v48, a[236:239] offset:3072
  v_mfma_f32_16x16x32_bf16 a[244:247], v[148:151], v[160:163], a[244:247]
  v_mfma_f32_16x16x32_bf16 a[244:247], v[144:147], v[164:167], a[244:247]
  buffer_load_dwordx4 v[100:103], v38, s[12:15], s0 offen offset:0 sc1
  v_mfma_f32_16x16x32_bf16 a[244:247], v[140:143], v[168:171], a[244:247]
  v_mfma_f32_16x16x32_bf16 a[244:247], v[136:139], v[172:175], a[244:247]
  v_mfma_f32_16x16x32_bf16 a[244:247], v[132:135], v[176:179], a[244:247]
  v_mfma_f32_16x16x32_bf16 a[244:247], v[128:131], v[180:183], a[244:247]
  ds_write_b128 v48, a[240:243] offset:4096
  v_mfma_f32_16x16x32_bf16 a[248:251], v[152:155], v[160:163], a[248:251]
  buffer_load_dwordx4 v[108:111], v38, s[12:15], s0 offen offset:1024 sc1
  v_mfma_f32_16x16x32_bf16 a[248:251], v[148:151], v[164:167], a[248:251]
  v_mfma_f32_16x16x32_bf16 a[248:251], v[144:147], v[168:171], a[248:251]
  buffer_load_dwordx4 v[116:119], v38, s[12:15], s0 offen offset:2048 sc1
  v_mfma_f32_16x16x32_bf16 a[248:251], v[140:143], v[172:175], a[248:251]
  v_mfma_f32_16x16x32_bf16 a[248:251], v[136:139], v[176:179], a[248:251]
  ds_write_b128 v48, a[244:247] offset:5120
  v_mfma_f32_16x16x32_bf16 a[248:251], v[132:135], v[180:183], a[248:251]
  buffer_load_dwordx4 v[124:127], v38, s[12:15], s38 offen offset:0 sc1
  v_mfma_f32_16x16x32_bf16 a[248:251], v[128:131], v[184:187], a[248:251]
  v_mfma_f32_16x16x32_bf16 a[252:255], v[156:159], v[160:163], a[252:255]
  v_mfma_f32_16x16x32_bf16 a[252:255], v[152:155], v[164:167], a[252:255]
  v_mfma_f32_16x16x32_bf16 a[252:255], v[148:151], v[168:171], a[252:255]
  buffer_load_dwordx4 v[64:67], v38, s[12:15], s0 offen offset:3072 sc1
  v_mfma_f32_16x16x32_bf16 a[252:255], v[144:147], v[172:175], a[252:255]
  v_mfma_f32_16x16x32_bf16 a[252:255], v[140:143], v[176:179], a[252:255]
  v_mfma_f32_16x16x32_bf16 a[252:255], v[136:139], v[180:183], a[252:255]
  v_mfma_f32_16x16x32_bf16 a[252:255], v[132:135], v[184:187], a[252:255]
  ds_write_b128 v48, a[248:251] offset:6144
  v_mfma_f32_16x16x32_bf16 a[252:255], v[128:131], v[188:191], a[252:255]
  buffer_load_dwordx4 v[72:75], v38, s[12:15], s38 offen offset:1024 sc1
  s_nop 6
  ds_write_b128 v48, a[252:255] offset:7168
  buffer_load_dwordx4 v[80:83], v38, s[12:15], s24 offen offset:0 sc1
  buffer_load_dwordx4 v[88:91], v38, s[12:15], s38 offen offset:2048 sc1
  buffer_load_dwordx4 v[96:99], v38, s[12:15], s24 offen offset:1024 sc1
  s_waitcnt lgkmcnt(0)
  s_barrier
  ds_read_b128 v[2:5], v49 offset:0
  ds_read_b128 v[6:9], v49 offset:40960
  ds_read_b128 v[10:13], v50 offset:0
  ds_read_b128 v[14:17], v50 offset:40960
  ds_read_b128 v[18:21], v49 offset:1024
  ds_read_b128 v[22:25], v49 offset:41984
  s_waitcnt vmcnt(12)
  v_mfma_f32_32x32x16_bf16 v[128:143], a[0:3], v[68:71], 0
  ds_read_b128 v[26:29], v50 offset:1024
  ds_read_b128 v[30:33], v50 offset:41984
  buffer_load_dwordx4 v[104:107], v38, s[12:15], s38 offen offset:3072 sc1
  s_add_u32 s38, s0, 114688
  v_mfma_f32_32x32x16_bf16 v[144:159], a[4:7], v[68:71], 0
  s_waitcnt vmcnt(12)
  v_mfma_f32_32x32x16_bf16 v[128:143], a[8:11], v[76:79], v[128:143]
  ds_read_b32 v54, v54 offset:40448
  ds_read_b32 v55, v55 offset:40448
  buffer_load_dwordx4 v[112:115], v38, s[12:15], s24 offen offset:2048 sc1
  v_mfma_f32_32x32x16_bf16 v[144:159], a[12:15], v[76:79], v[144:159]
  s_waitcnt vmcnt(12) lgkmcnt(8)
  v_add_f32 v2, v2, v6
  v_add_f32 v3, v3, v7
  v_add_f32 v4, v4, v8
  v_add_f32 v5, v5, v9
  v_mfma_f32_32x32x16_bf16 v[128:143], a[16:19], v[84:87], v[128:143]
  s_waitcnt lgkmcnt(6)
  v_add_f32 v10, v10, v14
  v_add_f32 v11, v11, v15
  v_add_f32 v12, v12, v16
  v_add_f32 v13, v13, v17
  v_cvt_pk_bf16_f32 v6, v2, v10
  v_cvt_pk_bf16_f32 v7, v3, v11
  v_mfma_f32_32x32x16_bf16 v[144:159], a[20:23], v[84:87], v[144:159]
  s_waitcnt vmcnt(11) lgkmcnt(4)
  v_add_f32 v18, v18, v22
  v_add_f32 v19, v19, v23
  v_add_f32 v20, v20, v24
  v_add_f32 v21, v21, v25
  v_cvt_pk_bf16_f32 v8, v4, v12
  v_cvt_pk_bf16_f32 v9, v5, v13
  v_mfma_f32_32x32x16_bf16 v[128:143], a[24:27], v[92:95], v[128:143]
  s_waitcnt lgkmcnt(2)
  buffer_load_dwordx4 v[120:123], v38, s[12:15], s38 offen offset:0 sc1
  v_add_f32 v26, v26, v30
  v_add_f32 v27, v27, v31
  v_add_f32 v28, v28, v32
  v_add_f32 v29, v29, v33
  v_cvt_pk_bf16_f32 v22, v18, v26
  v_mfma_f32_32x32x16_bf16 v[144:159], a[28:31], v[92:95], v[144:159]
  s_waitcnt vmcnt(11)
  buffer_load_dwordx4 v[192:195], v38, s[12:15], s24 offen offset:3072 sc1
  v_cvt_pk_bf16_f32 v23, v19, v27
  v_cvt_pk_bf16_f32 v24, v20, v28
  v_cvt_pk_bf16_f32 v25, v21, v29
  v_lshlrev_b32 v26, 16, v56
  v_and_b32 v27, 0xffff0000, v56
  v_mfma_f32_32x32x16_bf16 v[128:143], a[32:35], v[100:103], v[128:143]
  s_waitcnt lgkmcnt(0)
  v_sub_f32 v0, 1.0, v54
  v_sub_f32 v1, 1.0, v55
  v_lshlrev_b32 v28, 16, v57
  v_and_b32 v29, 0xffff0000, v57
  v_mul_f32 v10, v26, v0
  v_mul_f32 v11, v27, v0
  v_mfma_f32_32x32x16_bf16 v[144:159], a[36:39], v[100:103], v[144:159]
  s_waitcnt vmcnt(11)
  buffer_store_dwordx4 v[6:9], v38, s[12:15], s39 offen offset:0 sc1
  v_mul_f32 v18, v26, v1
  v_mfma_f32_32x32x16_bf16 v[128:143], a[40:43], v[108:111], v[128:143]
  v_mul_f32 v19, v27, v1
  v_lshlrev_b32 v30, 16, v58
  v_and_b32 v31, 0xffff0000, v58
  v_lshlrev_b32 v32, 16, v59
  v_and_b32 v33, 0xffff0000, v59
  v_mul_f32 v12, v28, v0
  v_mfma_f32_32x32x16_bf16 v[144:159], a[44:47], v[108:111], v[144:159]
  s_waitcnt vmcnt(11)
  buffer_store_dwordx4 v[22:25], v38, s[12:15], s39 offen offset:1024 sc1
  v_mul_f32 v13, v29, v0
  v_mfma_f32_32x32x16_bf16 v[128:143], a[48:51], v[116:119], v[128:143]
  v_mul_f32 v20, v28, v1
  v_mul_f32 v21, v29, v1
  v_mul_f32 v14, v30, v0
  v_mul_f32 v15, v31, v0
  v_mul_f32 v16, v32, v0
  v_mul_f32 v17, v33, v0
  v_mfma_f32_32x32x16_bf16 v[144:159], a[52:55], v[116:119], v[144:159]
  s_waitcnt vmcnt(11)
  buffer_load_dwordx4 v[196:199], v38, s[12:15], s38 offen offset:1024 sc1
  v_mul_f32 v22, v30, v1
  v_mul_f32 v23, v31, v1
  v_mul_f32 v24, v32, v1
  v_mul_f32 v25, v33, v1
  v_mfma_f32_32x32x16_bf16 v[160:175], a[0:3], v[124:127], 0
  v_mfma_f32_32x32x16_bf16 v[176:191], a[4:7], v[124:127], 0
  s_waitcnt vmcnt(11)
  buffer_load_dwordx4 v[200:203], v38, s[12:15], s26 offen offset:0 sc1
  v_mfma_f32_32x32x16_bf16 v[128:143], a[56:59], v[64:67], v[128:143]
  v_mfma_f32_32x32x16_bf16 v[144:159], a[60:63], v[64:67], v[144:159]
  s_waitcnt vmcnt(11)
  buffer_load_dwordx4 v[204:207], v38, s[12:15], s38 offen offset:2048 sc1
  v_mfma_f32_32x32x16_bf16 v[160:175], a[8:11], v[72:75], v[160:175]
  v_mfma_f32_32x32x16_bf16 v[176:191], a[12:15], v[72:75], v[176:191]
  s_waitcnt vmcnt(11)
  buffer_load_dwordx4 v[208:211], v38, s[12:15], s26 offen offset:1024 sc1
  v_mfma_f32_32x32x16_bf16 v[128:143], a[64:67], v[80:83], v[128:143]
  v_mfma_f32_32x32x16_bf16 v[144:159], a[68:71], v[80:83], v[144:159]
  s_waitcnt vmcnt(11)
  buffer_load_dwordx4 v[212:215], v38, s[12:15], s38 offen offset:3072 sc1
  s_add_u32 s38, s24, 114688
  v_mfma_f32_32x32x16_bf16 v[160:175], a[16:19], v[88:91], v[160:175]
  v_mfma_f32_32x32x16_bf16 v[176:191], a[20:23], v[88:91], v[176:191]
  s_waitcnt vmcnt(11)
  buffer_load_dwordx4 v[216:219], v38, s[12:15], s26 offen offset:2048 sc1
  v_mfma_f32_32x32x16_bf16 v[128:143], a[72:75], v[96:99], v[128:143]
  v_mfma_f32_32x32x16_bf16 v[144:159], a[76:79], v[96:99], v[144:159]
  s_waitcnt vmcnt(11)
  buffer_load_dwordx4 v[220:223], v38, s[12:15], s38 offen offset:0 sc1
  v_mfma_f32_32x32x16_bf16 v[160:175], a[24:27], v[104:107], v[160:175]
  v_mfma_f32_32x32x16_bf16 v[176:191], a[28:31], v[104:107], v[176:191]
  s_waitcnt vmcnt(11)
  buffer_load_dwordx4 v[224:227], v38, s[12:15], s26 offen offset:3072 sc1
  v_mfma_f32_32x32x16_bf16 v[128:143], a[80:83], v[112:115], v[128:143]
  v_mfma_f32_32x32x16_bf16 v[144:159], a[84:87], v[112:115], v[144:159]
  s_waitcnt vmcnt(11)
  buffer_load_dwordx4 v[228:231], v38, s[12:15], s38 offen offset:1024 sc1
  v_mfma_f32_32x32x16_bf16 v[160:175], a[32:35], v[120:123], v[160:175]
  v_mfma_f32_32x32x16_bf16 v[176:191], a[36:39], v[120:123], v[176:191]
  s_waitcnt vmcnt(11)
  buffer_load_dwordx4 v[232:235], v38, s[12:15], s28 offen offset:0 sc1
  v_mfma_f32_32x32x16_bf16 v[128:143], a[88:91], v[192:195], v[128:143]
  v_mfma_f32_32x32x16_bf16 v[144:159], a[92:95], v[192:195], v[144:159]
  buffer_load_dwordx4 v[236:239], v38, s[12:15], s38 offen offset:2048 sc1
  buffer_load_dwordx4 v[240:243], v38, s[12:15], s28 offen offset:1024 sc1
  s_waitcnt vmcnt(12)
  buffer_load_dwordx4 v[244:247], v38, s[12:15], s38 offen offset:3072 sc1
  s_add_u32 s38, s26, 114688
  s_waitcnt vmcnt(12)
  v_mfma_f32_32x32x16_bf16 v[160:175], a[40:43], v[196:199], v[160:175]
  v_mfma_f32_32x32x16_bf16 v[176:191], a[44:47], v[196:199], v[176:191]
  s_mov_b64 exec, 1
  buffer_store_dword v40, off, s[12:15], s40 sc1
  s_mov_b64 exec, -1
  s_waitcnt vmcnt(12)
  v_mfma_f32_32x32x16_bf16 v[128:143], a[96:99], v[200:203], v[128:143]
  buffer_load_dwordx4 v[248:251], v38, s[12:15], s28 offen offset:2048 sc1
  v_mfma_f32_32x32x16_bf16 v[144:159], a[100:103], v[200:203], v[144:159]
  s_waitcnt vmcnt(12)
  v_mfma_f32_32x32x16_bf16 v[160:175], a[48:51], v[204:207], v[160:175]
  buffer_load_dwordx4 v[252:255], v38, s[12:15], s38 offen offset:0 sc1
  v_mfma_f32_32x32x16_bf16 v[176:191], a[52:55], v[204:207], v[176:191]
  s_waitcnt vmcnt(12)
  v_mfma_f32_32x32x16_bf16 v[128:143], a[104:107], v[208:211], v[128:143]
  buffer_load_dwordx4 v[68:71], v38, s[12:15], s28 offen offset:3072 sc1
  v_mfma_f32_32x32x16_bf16 v[144:159], a[108:111], v[208:211], v[144:159]
  s_waitcnt vmcnt(12)
  v_mfma_f32_32x32x16_bf16 v[160:175], a[56:59], v[212:215], v[160:175]
  buffer_load_dwordx4 v[76:79], v38, s[12:15], s38 offen offset:1024 sc1
  v_mfma_f32_32x32x16_bf16 v[176:191], a[60:63], v[212:215], v[176:191]
  s_waitcnt vmcnt(12)
  v_mfma_f32_32x32x16_bf16 v[128:143], a[112:115], v[216:219], v[128:143]
  buffer_load_dwordx4 v[84:87], v38, s[12:15], s30 offen offset:0 sc1
  v_mfma_f32_32x32x16_bf16 v[144:159], a[116:119], v[216:219], v[144:159]
  s_waitcnt vmcnt(12)
  v_mfma_f32_32x32x16_bf16 v[160:175], a[64:67], v[220:223], v[160:175]
  buffer_load_dwordx4 v[92:95], v38, s[12:15], s38 offen offset:2048 sc1
  v_mfma_f32_32x32x16_bf16 v[176:191], a[68:71], v[220:223], v[176:191]
  s_waitcnt vmcnt(12)
  v_mfma_f32_32x32x16_bf16 v[128:143], a[120:123], v[224:227], v[128:143]
  buffer_load_dwordx4 v[100:103], v38, s[12:15], s30 offen offset:1024 sc1
  v_mfma_f32_32x32x16_bf16 v[144:159], a[124:127], v[224:227], v[144:159]
  s_waitcnt vmcnt(12)
  v_mfma_f32_32x32x16_bf16 v[160:175], a[72:75], v[228:231], v[160:175]
  buffer_load_dwordx4 v[108:111], v38, s[12:15], s38 offen offset:3072 sc1
  s_add_u32 s38, s28, 114688
  v_mfma_f32_32x32x16_bf16 v[176:191], a[76:79], v[228:231], v[176:191]
  s_waitcnt vmcnt(12)
  v_mfma_f32_32x32x16_bf16 v[128:143], a[128:131], v[232:235], v[128:143]
  buffer_load_dwordx4 v[116:119], v38, s[12:15], s30 offen offset:2048 sc1
  v_mfma_f32_32x32x16_bf16 v[144:159], a[132:135], v[232:235], v[144:159]
  s_waitcnt vmcnt(12)
  v_mfma_f32_32x32x16_bf16 v[160:175], a[80:83], v[236:239], v[160:175]
  buffer_load_dwordx4 v[124:127], v38, s[12:15], s38 offen offset:0 sc1
  v_mfma_f32_32x32x16_bf16 v[176:191], a[84:87], v[236:239], v[176:191]
  s_waitcnt vmcnt(12)
  v_mfma_f32_32x32x16_bf16 v[128:143], a[136:139], v[240:243], v[128:143]
  buffer_load_dwordx4 v[64:67], v38, s[12:15], s30 offen offset:3072 sc1
  v_mfma_f32_32x32x16_bf16 v[144:159], a[140:143], v[240:243], v[144:159]
  s_waitcnt vmcnt(12)
  v_mfma_f32_32x32x16_bf16 v[160:175], a[88:91], v[244:247], v[160:175]
  buffer_load_dwordx4 v[72:75], v38, s[12:15], s38 offen offset:1024 sc1
  v_mfma_f32_32x32x16_bf16 v[176:191], a[92:95], v[244:247], v[176:191]
  buffer_load_dwordx4 v[80:83], v38, s[12:15], s36 offen offset:0 sc1
  buffer_load_dwordx4 v[88:91], v38, s[12:15], s38 offen offset:2048 sc1
  buffer_load_dwordx4 v[96:99], v38, s[12:15], s36 offen offset:1024 sc1
  buffer_load_dwordx4 v[104:107], v38, s[12:15], s38 offen offset:3072 sc1
  s_add_u32 s38, s30, 114688
  s_waitcnt vmcnt(15)
  buffer_load_dwordx4 v[112:115], v38, s[12:15], s36 offen offset:2048 sc1
  v_mfma_f32_32x32x16_bf16 v[128:143], a[144:147], v[248:251], v[128:143]
  v_mfma_f32_32x32x16_bf16 v[144:159], a[148:151], v[248:251], v[144:159]
  s_waitcnt vmcnt(15)
  v_mfma_f32_32x32x16_bf16 v[160:175], a[96:99], v[252:255], v[160:175]
  buffer_load_dwordx4 v[120:123], v38, s[12:15], s38 offen offset:0 sc1
  v_mfma_f32_32x32x16_bf16 v[176:191], a[100:103], v[252:255], v[176:191]
  s_waitcnt vmcnt(15)
  v_mfma_f32_32x32x16_bf16 v[128:143], a[152:155], v[68:71], v[128:143]
  buffer_load_dwordx4 v[192:195], v38, s[12:15], s36 offen offset:3072 sc1
  v_mfma_f32_32x32x16_bf16 v[144:159], a[156:159], v[68:71], v[144:159]
  s_waitcnt vmcnt(15)
  v_mfma_f32_32x32x16_bf16 v[160:175], a[104:107], v[76:79], v[160:175]
  buffer_load_dwordx4 v[196:199], v38, s[12:15], s38 offen offset:1024 sc1
  v_mfma_f32_32x32x16_bf16 v[176:191], a[108:111], v[76:79], v[176:191]
  s_waitcnt vmcnt(15)
  v_mfma_f32_32x32x16_bf16 v[128:143], a[160:163], v[84:87], v[128:143]
  buffer_load_dwordx4 v[200:203], v38, s[12:15], s38 offen offset:2048 sc1
  v_mfma_f32_32x32x16_bf16 v[144:159], a[164:167], v[84:87], v[144:159]
  s_waitcnt vmcnt(15)
  v_mfma_f32_32x32x16_bf16 v[160:175], a[112:115], v[92:95], v[160:175]
  buffer_load_dwordx4 a[220:223], v38, s[12:15], s37 offen offset:3072 sc1
  v_mfma_f32_32x32x16_bf16 v[176:191], a[116:119], v[92:95], v[176:191]
  s_waitcnt vmcnt(15)
  v_mfma_f32_32x32x16_bf16 v[128:143], a[168:171], v[100:103], v[128:143]
  buffer_load_dwordx4 v[204:207], v38, s[12:15], s38 offen offset:3072 sc1
  s_add_u32 s38, s36, 114688
  v_mfma_f32_32x32x16_bf16 v[144:159], a[172:175], v[100:103], v[144:159]
  s_waitcnt vmcnt(15)
  v_mfma_f32_32x32x16_bf16 v[160:175], a[120:123], v[108:111], v[160:175]
  buffer_load_dwordx4 v[208:211], v38, s[12:15], s38 offen offset:0 sc1
  v_mfma_f32_32x32x16_bf16 v[176:191], a[124:127], v[108:111], v[176:191]
  s_waitcnt vmcnt(15)
  v_mfma_f32_32x32x16_bf16 v[128:143], a[176:179], v[116:119], v[128:143]
  buffer_load_dword v36, v51, s[12:15], s41 offen sc1
  buffer_load_dwordx4 v[212:215], v38, s[12:15], s38 offen offset:1024 sc1
  v_mfma_f32_32x32x16_bf16 v[144:159], a[180:183], v[116:119], v[144:159]
  s_waitcnt vmcnt(16)
  v_mfma_f32_32x32x16_bf16 v[160:175], a[128:131], v[124:127], v[160:175]
  buffer_load_dwordx4 v[216:219], v38, s[12:15], s38 offen offset:2048 sc1
  v_mfma_f32_32x32x16_bf16 v[176:191], a[132:135], v[124:127], v[176:191]
  s_waitcnt vmcnt(16)
  v_mfma_f32_32x32x16_bf16 v[128:143], a[184:187], v[64:67], v[128:143]
  buffer_load_dwordx4 v[220:223], v38, s[12:15], s38 offen offset:3072 sc1
  v_mfma_f32_32x32x16_bf16 v[144:159], a[188:191], v[64:67], v[144:159]
  s_waitcnt vmcnt(16)
  v_mfma_f32_32x32x16_bf16 v[160:175], a[136:139], v[72:75], v[160:175]
  v_mfma_f32_32x32x16_bf16 v[176:191], a[140:143], v[72:75], v[176:191]
  s_waitcnt vmcnt(15)
  v_mfma_f32_32x32x16_bf16 v[128:143], a[192:195], v[80:83], v[128:143]
  v_mfma_f32_32x32x16_bf16 v[144:159], a[196:199], v[80:83], v[144:159]
  s_waitcnt vmcnt(14)
  v_mfma_f32_32x32x16_bf16 v[160:175], a[144:147], v[88:91], v[160:175]
  v_mfma_f32_32x32x16_bf16 v[176:191], a[148:151], v[88:91], v[176:191]
  s_waitcnt vmcnt(13)
  v_mfma_f32_32x32x16_bf16 v[128:143], a[200:203], v[96:99], v[128:143]
  v_mfma_f32_32x32x16_bf16 v[144:159], a[204:207], v[96:99], v[144:159]
  s_waitcnt vmcnt(12)
  v_mfma_f32_32x32x16_bf16 v[160:175], a[152:155], v[104:107], v[160:175]
  v_mfma_f32_32x32x16_bf16 v[176:191], a[156:159], v[104:107], v[176:191]
  s_waitcnt vmcnt(11)
  v_mfma_f32_32x32x16_bf16 v[128:143], a[208:211], v[112:115], v[128:143]
  v_mfma_f32_32x32x16_bf16 v[144:159], a[212:215], v[112:115], v[144:159]
  s_waitcnt vmcnt(10)
  v_mfma_f32_32x32x16_bf16 v[160:175], a[160:163], v[120:123], v[160:175]
  v_mfma_f32_32x32x16_bf16 v[176:191], a[164:167], v[120:123], v[176:191]
  s_waitcnt vmcnt(9)
  v_mfma_f32_32x32x16_bf16 v[128:143], a[216:219], v[192:195], v[128:143]
  s_waitcnt vmcnt(6)
  v_mfma_f32_32x32x16_bf16 v[144:159], a[220:223], v[192:195], v[144:159]
  v_mfma_f32_32x32x16_bf16 v[160:175], a[168:171], v[196:199], v[160:175]
  v_mfma_f32_32x32x16_bf16 v[176:191], a[172:175], v[196:199], v[176:191]
  s_waitcnt vmcnt(3)
  v_cmp_ne_u32 vcc, s61, v36
  s_cbranch_vccnz Lspin_a
Lok_a:
  buffer_load_dword v2, v52, s[12:15], s42 offen offset:0 sc1
  v_mfma_f32_32x32x16_bf16 v[160:175], a[176:179], v[200:203], v[160:175]
  buffer_load_dword v6, v52, s[12:15], s42 offen offset:128 sc1
  s_add_u32 s42, s42, 8192
  buffer_load_dword v3, v52, s[12:15], s42 offen offset:0 sc1
  buffer_load_dword v7, v52, s[12:15], s42 offen offset:128 sc1
  s_add_u32 s42, s42, 8192
  buffer_load_dword v4, v52, s[12:15], s42 offen offset:0 sc1
  v_mfma_f32_32x32x16_bf16 v[176:191], a[180:183], v[200:203], v[176:191]
  buffer_load_dword v8, v52, s[12:15], s42 offen offset:128 sc1
  s_add_u32 s42, s42, 8192
  buffer_load_dword v5, v52, s[12:15], s42 offen offset:0 sc1
  buffer_load_dword v9, v52, s[12:15], s42 offen offset:128 sc1
  v_mfma_f32_32x32x16_bf16 v[160:175], a[184:187], v[204:207], v[160:175]
  ds_write_b128 v39, v[128:131] offset:0
  v_mfma_f32_32x32x16_bf16 v[176:191], a[188:191], v[204:207], v[176:191]
  ds_write_b128 v39, v[132:135] offset:1024
  v_mfma_f32_32x32x16_bf16 v[160:175], a[192:195], v[208:211], v[160:175]
  ds_write_b128 v39, v[136:139] offset:2048
  v_mfma_f32_32x32x16_bf16 v[176:191], a[196:199], v[208:211], v[176:191]
  s_waitcnt vmcnt(10)
  ds_write_b128 v39, v[140:143] offset:3072
  v_mfma_f32_32x32x16_bf16 v[160:175], a[200:203], v[212:215], v[160:175]
  s_waitcnt vmcnt(9)
  ds_write_b128 v39, v[144:147] offset:4096
  v_mfma_f32_32x32x16_bf16 v[160:175], a[208:211], v[216:219], v[160:175]
  s_waitcnt vmcnt(8)
  ds_write_b128 v39, v[148:151] offset:5120
  v_mfma_f32_32x32x16_bf16 v[160:175], a[216:219], v[220:223], v[160:175]
  v_mfma_f32_32x32x16_bf16 v[176:191], a[204:207], v[212:215], v[176:191]
  v_mfma_f32_32x32x16_bf16 v[176:191], a[212:215], v[216:219], v[176:191]
  v_mfma_f32_32x32x16_bf16 v[176:191], a[220:223], v[220:223], v[176:191]
  s_nop 8
  ds_write_b128 v39, v[160:163] offset:8192
  ds_write_b128 v39, v[164:167] offset:9216
  ds_write_b128 v39, v[168:171] offset:10240
  ds_write_b128 v39, v[172:175] offset:11264
  ds_write_b128 v39, v[176:179] offset:12288
  s_waitcnt lgkmcnt(5)
  ds_write_b128 v39, v[180:183] offset:13312
  s_barrier
  ds_read_b128 v[224:227], v60 offset:0
  ds_read_b128 v[232:235], v61 offset:2048
  ds_read_b128 v[240:243], v62 offset:4096
  ds_read_b128 v[228:231], v60 offset:1024
  ds_read_b128 v[236:239], v61 offset:3072
  ds_read_b128 v[244:247], v62 offset:5120
  s_waitcnt vmcnt(7)
  v_lshlrev_b32 v26, 16, v2
  v_and_b32 v27, 0xffff0000, v2
  v_fmac_f32 v10, v26, v54
  v_fmac_f32 v11, v27, v54
  v_fmac_f32 v10, v152, v0
  v_fmac_f32 v11, v153, v0
  s_waitcnt vmcnt(6)
  v_lshlrev_b32 v26, 16, v6
  v_and_b32 v27, 0xffff0000, v6
  s_waitcnt vmcnt(5)
  v_lshlrev_b32 v28, 16, v3
  v_and_b32 v29, 0xffff0000, v3
  v_fmac_f32 v12, v28, v54
  v_fmac_f32 v13, v29, v54
  v_fmac_f32 v12, v154, v0
  v_fmac_f32 v13, v155, v0
  v_fmac_f32 v18, v26, v55
  v_fmac_f32 v19, v27, v55
  v_fmac_f32 v18, v184, v1
  s_waitcnt vmcnt(3)
  v_lshlrev_b32 v30, 16, v4
  v_and_b32 v31, 0xffff0000, v4
  v_fmac_f32 v14, v30, v54
  v_fmac_f32 v15, v31, v54
  v_fmac_f32 v14, v156, v0
  v_fmac_f32 v15, v157, v0
  v_lshlrev_b32 v28, 16, v7
  v_and_b32 v29, 0xffff0000, v7
  v_fmac_f32 v20, v28, v55
  v_fmac_f32 v19, v185, v1
  s_waitcnt vmcnt(1) lgkmcnt(4)
  s_barrier
  ds_read_b128 v[128:131], v60 offset:8192
  ds_read_b128 v[136:139], v61 offset:10240
  ds_read_b128 v[132:135], v60 offset:9216
  ds_read_b128 v[140:143], v61 offset:11264
  ds_read_b128 v[144:147], v62 offset:12288
  v_add_f32 v224, v224, v232
  v_add_f32 v225, v225, v233
  s_waitcnt lgkmcnt(6)
  ds_read_b128 v[148:151], v62 offset:13312
  v_lshlrev_b32 v32, 16, v5
  v_and_b32 v33, 0xffff0000, v5
  v_add_f32 v226, v226, v234
  v_add_f32 v227, v227, v235
  v_add_f32 v224, v224, v240
  v_add_f32 v225, v225, v241
  v_add_f32 v228, v228, v236
  v_add_f32 v229, v229, v237
  s_waitcnt lgkmcnt(6)
  v_fmac_f32 v16, v32, v54
  v_fmac_f32 v17, v33, v54
  v_add_f32 v230, v230, v238
  v_add_f32 v231, v231, v239
  v_add_f32 v226, v226, v242
  v_add_f32 v227, v227, v243
  v_fmac_f32 v10, v224, v0
  v_fmac_f32 v11, v225, v0
  v_fmac_f32 v16, v158, v0
  v_add_f32 v228, v228, v244
  v_add_f32 v229, v229, v245
  s_waitcnt lgkmcnt(4)
  v_fmac_f32 v17, v159, v0
  v_add_f32 v230, v230, v246
  v_add_f32 v231, v231, v247
  v_fmac_f32 v12, v226, v0
  v_fmac_f32 v13, v227, v0
  v_cvt_pk_bf16_f32 v10, v10, v11
  v_pk_add_f32 v[128:129], v[128:129], v[136:137]
  v_fmac_f32 v14, v228, v0
  v_fmac_f32 v15, v229, v0
  s_waitcnt lgkmcnt(1)
  v_fmac_f32 v16, v230, v0
  v_fmac_f32 v17, v231, v0
  v_cvt_pk_bf16_f32 v11, v12, v13
  v_pk_add_f32 v[130:131], v[130:131], v[138:139]
  v_cvt_pk_bf16_f32 v12, v14, v15
  v_cvt_pk_bf16_f32 v13, v16, v17
  v_pk_add_f32 v[132:133], v[132:133], v[140:141]
  v_pk_add_f32 v[134:135], v[134:135], v[142:143]
  s_waitcnt vmcnt(0)
  buffer_store_dwordx4 v[10:13], v53, s[16:19], s43 offen
  v_pk_add_f32 v[128:129], v[128:129], v[144:145]
  v_lshlrev_b32 v30, 16, v8
  v_and_b32 v31, 0xffff0000, v8
  s_waitcnt lgkmcnt(0)
  v_lshlrev_b32 v32, 16, v9
  v_and_b32 v33, 0xffff0000, v9
  v_fmac_f32 v21, v29, v55
  v_pk_add_f32 v[130:131], v[130:131], v[146:147]
  v_fmac_f32 v22, v30, v55
  v_fmac_f32 v23, v31, v55
  v_fmac_f32 v24, v32, v55
  v_fmac_f32 v25, v33, v55
  v_fmac_f32 v20, v186, v1
  v_pk_add_f32 v[132:133], v[132:133], v[148:149]
  s_add_u32 s43, s43, 28672
  v_fmac_f32 v21, v187, v1
  v_pk_add_f32 v[134:135], v[134:135], v[150:151]
  v_pk_fma_f32 v[18:19], v[128:129], v[0:1], v[18:19] op_sel:[0,1,0] op_sel_hi:[1,1,1]
  v_fmac_f32 v22, v188, v1
  v_fmac_f32 v23, v189, v1
  v_fmac_f32 v24, v190, v1
  v_fmac_f32 v25, v191, v1
  v_pk_fma_f32 v[20:21], v[130:131], v[0:1], v[20:21] op_sel:[0,1,0] op_sel_hi:[1,1,1]
  v_pk_fma_f32 v[22:23], v[132:133], v[0:1], v[22:23] op_sel:[0,1,0] op_sel_hi:[1,1,1]
  v_pk_fma_f32 v[24:25], v[134:135], v[0:1], v[24:25] op_sel:[0,1,0] op_sel_hi:[1,1,1]
  v_cvt_pk_bf16_f32 v18, v18, v19
  v_cvt_pk_bf16_f32 v19, v20, v21
  v_cvt_pk_bf16_f32 v20, v22, v23
  v_cvt_pk_bf16_f32 v21, v24, v25
  buffer_store_dwordx4 v[18:21], v53, s[16:19], s43 offen
  s_or_b32 s53, s2, s3
  s_cbranch_scc1 Lnoep
  s_mov_b64 exec, 1
  buffer_store_dword v40, off, s[12:15], 0 sc1
Lnoep:
Lend:
  s_endpgm
Lspin_w:
  s_mov_b32 s63, 0
Lloop_w:
  buffer_load_dword v36, v44, s[12:15], s66 offen sc1
  s_add_u32 s63, s63, 1
  s_cmp_lt_u32 s63, 65536
  s_waitcnt vmcnt(0)
  v_cmp_ne_u32 vcc, s61, v36
  s_cbranch_vccz Lok_w
  s_cbranch_scc1 Lloop_w
  s_branch Lok_w
Lspin_u:
  s_mov_b32 s63, 0
Lloop_u:
  buffer_load_dwordx2 v[36:37], v33, s[12:15], s66 offen sc1
  s_add_u32 s63, s63, 1
  s_cmp_lt_u32 s63, 65536
  s_waitcnt vmcnt(0)
  v_cmp_ne_u32 vcc, s61, v36
  s_cbranch_vccz Lok_u
  s_cbranch_scc1 Lloop_u
  s_branch Lok_u
Lspin_h:
  s_mov_b32 s63, 0
Lloop_h:
  buffer_load_dword v36, v35, s[12:15], s34 offen sc1
  s_add_u32 s63, s63, 1
  s_cmp_lt_u32 s63, 65536
  s_waitcnt vmcnt(0)
  v_cmp_ne_u32 vcc, s61, v36
  s_cbranch_vccz Lok_h
  s_cbranch_scc1 Lloop_h
  s_branch Lok_h
Lspin_a:
  s_mov_b32 s63, 0
Lloop_a:
  buffer_load_dword v36, v51, s[12:15], s41 offen sc1
  s_add_u32 s63, s63, 1
  s_cmp_lt_u32 s63, 65536
  s_waitcnt vmcnt(0)
  v_cmp_ne_u32 vcc, s61, v36
  s_cbranch_vccz Lok_a
  s_cbranch_scc1 Lloop_a
  s_branch Lok_a
Lhelp:
  s_add_u32 s2, s2, 32
  s_cmp_ge_u32 s2, 32
  s_cbranch_scc1 Lend2
  v_lshrrev_b32 v2, 6, v0
  v_and_b32 v1, 63, v0
  s_mul_i32 s53, s2, 37
  v_readfirstlane_b32 s3, v2
  s_lshr_b32 s53, s53, 8
  s_mul_i32 s54, s53, 7
  s_sub_u32 s54, s2, s54
  s_mul_i32 s64, s53, 401408
  s_lshl_b32 s54, s54, 7
  s_add_u32 s64, s64, s54
  s_mul_i32 s52, s3, 40960
  s_mul_i32 s50, s3, 7
  s_mul_i32 s59, s2, 28
  s_add_u32 s59, s59, s50
  s_lshl_b32 s59, s59, 11
  s_add_u32 s59, s59, 12582912
  s_lshl_b32 s62, s2, 2
  s_add_u32 s62, s62, s3
  s_lshl_b32 s62, s62, 7
  s_add_u32 s62, s62, 180224
  v_lshrrev_b32 v2, 3, v1
  v_mul_u32_u24 v2, 896, v2
  v_lshrrev_b32 v3, 2, v1
  v_and_b32 v3, 4, v3
  v_xor_b32 v3, v3, v1
  v_and_b32 v3, 7, v3
  v_lshl_add_u32 v2, v3, 4, v2
  v_add_u32 v3, 12288, v2
  v_lshrrev_b32 v4, 5, v1
  v_bfe_u32 v5, v1, 2, 2
  v_lshl_add_u32 v4, v4, 4, v5
  v_lshlrev_b32 v4, 7, v4
  v_and_b32 v5, 1, v1
  v_lshl_add_u32 v4, v5, 4, v4
  v_and_b32 v5, 16, v1
  v_lshl_add_u32 v4, v5, 1, v4
  v_and_b32 v5, 2, v1
  v_lshl_add_u32 v4, v5, 2, v4
  v_and_b32 v5, 8, v1
  v_lshl_add_u32 v4, v5, 3, v4
  s_xor_b32 s53, s53, 3
  s_lshl_b32 s53, s53, 5
  v_xor_b32 v4, s53, v4
  v_add_u32 v4, s52, v4
  v_xor_b32 v5, 64, v4
  v_lshlrev_b32 v6, 4, v1
  v_lshlrev_b32 v7, 16, v0
  s_mov_b32 s14, 14188544
  s_mov_b32 s15, 0x20000
  s_mov_b32 s18, 1835008
  s_mov_b32 s19, 0x20000
  s_mov_b32 s22, 1605632
  s_mov_b32 s23, 0x20000
  s_waitcnt lgkmcnt(0)
  s_load_dword s61, s[12:13], 0
  s_mov_b32 s20, s38
  s_mov_b32 s21, s39
  buffer_load_dword v8, v7, s[12:15], 0 offen offset:2048
  buffer_load_dword v9, v7, s[16:19], 0 offen
Lend2:
  s_waitcnt vmcnt(0)
  s_endpgm
.section .rodata,"a"
.p2align 6
.amdhsa_kernel gated_mix__ssm_conv_s4d__dense_activation_squared_relu__prompt_kernel
  .amdhsa_next_free_vgpr 512
  .amdhsa_next_free_sgpr 102
  .amdhsa_accum_offset 256
  .amdhsa_group_segment_fixed_size 0
  .amdhsa_kernarg_size 128
  .amdhsa_user_sgpr_count 2
  .amdhsa_user_sgpr_kernarg_segment_ptr 1
  .amdhsa_system_sgpr_workgroup_id_x 1
.end_amdhsa_kernel
```
